```python
import torch

def _softmax(x, axis=-1):
    return torch.softmax(x, dim=axis)
def _gelu(x):
    return torch.nn.functional.gelu(x, approximate="tanh")
def _silu(x):
    return torch.nn.functional.silu(x)
def _sigmoid(x):
    return torch.sigmoid(x)
def _layernorm(x, axis=-1, eps=1e-5):
    m = x.mean(dim=axis, keepdim=True)
    v = x.var(dim=axis, keepdim=True, unbiased=False)
    return (x - m) / torch.sqrt(v + eps)
def _scatter_add(tgt, idx, src, axis=0):
    return tgt.clone().index_add_(axis, idx, src)
def _segment_sum(src, seg, n):
    out = torch.zeros((n,) + src.shape[1:], dtype=src.dtype)
    return out.index_add_(0, seg, src)
def _pad(x, pw):
    flat = tuple(v for pair in reversed(pw) for v in pair)
    return torch.nn.functional.pad(x, flat)

kernel_name = 'recurrent_scan__ssm_conv_h3__dense_activation_gelu__prompt'

def setup_inputs():

    _w = (lambda a: (lambda t: t.to(torch.bfloat16) if t.is_floating_point() else t)(torch.as_tensor(a)))
    def _A_setup():
        B, S, D = 1, 2048, 512
        ks = 4
        return {
            "q": _w((lambda *s: torch.randn(*s, dtype=torch.bfloat16) * 0.05)(B, S, D)),
            "k": _w((lambda *s: torch.randn(*s, dtype=torch.bfloat16) * 0.8)(B, S, D)),
            "v": _w((lambda *s: torch.randn(*s, dtype=torch.bfloat16) * 0.8)(B, S, D)),
            "shift_k": _w((lambda *s: torch.randn(*s, dtype=torch.bfloat16) * 0.8)(D, ks) * 0.5),
            "ssm_k": _w((lambda *s: torch.randn(*s, dtype=torch.bfloat16) * 0.8)(D, S) * (1.0 / S ** 0.5)),
            "ssm_D": _w((lambda *s: torch.randn(*s, dtype=torch.bfloat16) * 0.8)(D)),
        }
    _A_in = _A_setup()

    def _B_setup():
        B, S, D, F = 1, 2048, 512, 1792
        return {
            "x": _w((lambda *s: torch.randn(*s, dtype=torch.bfloat16) * 0.05)(B, S, D)),
            "w1": _w((lambda *s: torch.randn(*s, dtype=torch.bfloat16) * 0.2)(D, F) * (D ** -0.5)),
            "b1": _w((lambda *s: torch.randn(*s, dtype=torch.bfloat16) * 0.2)(F) * 0.01),
            "w2": _w((lambda *s: torch.randn(*s, dtype=torch.bfloat16) * 0.2)(F, D) * (F ** -0.5)),
            "b2": _w((lambda *s: torch.randn(*s, dtype=torch.bfloat16) * 0.2)(D) * 0.01),
        }
    _B_in = _B_setup()

    return {
        "A_q": _A_in["q"],
        "A_k": _A_in["k"],
        "A_v": _A_in["v"],
        "A_shift_k": _A_in["shift_k"],
        "A_ssm_k": _A_in["ssm_k"],
        "A_ssm_D": _A_in["ssm_D"],
        "B_x": _B_in["x"],
        "B_w1": _B_in["w1"],
        "B_b1": _B_in["b1"],
        "B_w2": _B_in["w2"],
        "B_b2": _B_in["b2"],
    }

def reference(A_q, A_k, A_v, A_shift_k, A_ssm_k, A_ssm_D, B_x, B_w1, B_b1, B_w2, B_b2):
    def _A_ref(q, k, v, shift_k, ssm_k, ssm_D):
        B, S, D = q.shape
        ks = shift_k.shape[-1]
        k_pad = _pad(k, ((0, 0), (ks - 1, 0), (0, 0)))
        k_shift = torch.zeros_like(k)
        for t in range(ks):
            k_shift = k_shift + k_pad[:, t:t + S, :] * shift_k[:, ks - 1 - t][None, None, :]
        kv = k_shift * v
        L = 2 * S
        kv_pad = _pad(kv, ((0, 0), (0, S), (0, 0)))
        kf_pad = _pad(ssm_k, ((0, 0), (0, S)))
        kv_f = (lambda x, axes=(-2,-1): torch.fft.rfft2(x.float(), dim=axes))(kv_pad[:, None, :, :], axes=(1, 2))
        kf_f = (lambda x, axes=(-2,-1): torch.fft.rfft2(x.float(), dim=axes))(kf_pad[:, None, :], axes=(1, 2))
        kf_f = (lambda x, *d: x.permute(*d))(kf_f, 1, 2, 0)
        y_f = kv_f * kf_f[None, :, :, :]
        y = (lambda x, s, axes=(-2,-1): torch.fft.irfft2(x, s=s, dim=axes).to(torch.bfloat16))(y_f, (1, L), axes=(1, 2))[:, 0, :S, :]
        y = y + kv * ssm_D[None, None, :]
        return q * y

    def _B_ref(x, w1, b1, w2, b2):
        h = torch.einsum("bsd,df->bsf", x, w1) + b1
        h = _gelu(h)
        return torch.einsum("bsf,fd->bsd", h, w2) + b2

    x = A_q
    xn = _layernorm(x, axis=-1)
    s = _A_ref(xn, A_k, A_v, A_shift_k, A_ssm_k, A_ssm_D)
    g = _silu(_B_ref(xn, B_w1, B_b1, B_w2, B_b2))
    return x + s * g
```

```asm
; @launch grid=(256,1,1) block=(512,1,1) lds=160256
.amdgcn_target "amdgcn-amd-amdhsa--gfx950"
.text
.globl recurrent_scan__ssm_conv_h3__dense_activation_gelu__prompt_kernel
.p2align 12
.fill 832, 4, 0xbf800000
.p2align 8
.type recurrent_scan__ssm_conv_h3__dense_activation_gelu__prompt_kernel,@function
recurrent_scan__ssm_conv_h3__dense_activation_gelu__prompt_kernel:
  s_cmp_ge_u32 s2, 256
  s_cbranch_scc1 L_end
  s_load_dwordx2 s[4:5], s[0:1], 0
  s_load_dwordx2 s[24:25], s[0:1], 56
  s_load_dwordx2 s[48:49], s[0:1], 104
  s_mov_b64 exec, -1
  v_lshrrev_b32 v1, 6, v0
  v_and_b32 v255, 63, v0
  v_readfirstlane_b32 s3, v1
  s_and_b32 s54, s2, 7
  s_lshr_b32 s55, s2, 3
  s_lshr_b32 s57, s2, 5
  s_and_b32 s62, s55, 3
  s_lshl2_add_u32 s56, s54, s62
  s_lshr_b32 s58, s54, 1
  s_lshl2_add_u32 s58, s58, s62
  s_bitcmp1_b32 s2, 0
  s_cselect_b32 s59, 6, -1
  s_add_u32 s59, s59, s57
  s_xor_b32 s57, s57, 3
  s_and_b32 s61, s3, 3
  v_lshlrev_b32 v252, 4, v255
  v_mov_b32 v254, 0
  v_mov_b32 v253, 1
  s_cmp_lt_u32 s3, 4
  s_cbranch_scc1 L_F
  s_mov_b32 s6, 2097152
  s_mov_b32 s7, 0x20000
  s_mov_b32 s26, 1835008
  s_mov_b32 s27, 0x20000
  v_lshrrev_b32 v3, 3, v255
  v_and_b32 v4, 7, v255
  v_lshrrev_b32 v5, 4, v255
  s_lshl_b32 s69, s61, 10
  s_cmp_eq_u32 s57, 3
  s_cbranch_scc1 L_C_aux
  s_and_b32 s63, s61, 1
  s_lshl_b32 s63, s63, 2
  v_add_u32 v6, s63, v5
  v_xor_b32 v6, v6, v4
  v_lshlrev_b32 v6, 4, v6
  v_lshl_add_u32 v6, v3, 10, v6
  s_lshl4_add_u32 s63, s58, s61
  s_lshl_b32 s63, s63, 13
  v_add_u32 v232, s63, v6
  v_add_u32 v233, 32768, v232
  v_add_u32 v234, 65536, v232
  v_add_u32 v235, 98304, v232
  v_and_b32 v6, 15, v255
  s_and_b32 s63, s61, 2
  s_lshl_b32 s63, s63, 2
  v_lshl_add_u32 v7, v5, 1, s63
  v_xor_b32 v6, v6, v7
  v_lshlrev_b32 v6, 4, v6
  v_mul_u32_u24 v7, 3584, v5
  s_mul_i32 s63, s61, 56
  s_add_u32 s63, s63, s59
  s_lshl_b32 s63, s63, 8
  v_add3_u32 v236, v6, v7, s63
  v_add_u32 v237, 57344, v236
  v_add_u32 v238, 114688, v236
  v_add_u32 v239, 172032, v236
  s_add_u32 s18, s57, s55
  s_and_b32 s18, s18, 3
  s_lshr_b32 s19, s2, 1
  s_xor_b32 s19, s19, s2
  s_and_b32 s19, s19, 1
  s_and_b32 s19, s2, 6
  s_lshl2_add_u32 s19, s2, s19
  s_and_b32 s19, s19, 7
  s_bitcmp1_b32 s18, 0
  s_cselect_b32 s66, 1, 0
  s_add_u32 s66, s66, s19
  s_bfe_u32 s71, s66, 0x30000
  s_lshl_b32 s70, s71, 7
  s_mul_i32 s71, s71, 229376
  s_add_u32 m0, s69, 16384
  s_waitcnt lgkmcnt(0)
  buffer_load_dwordx4 v236, s[24:27], s71 offen lds
  s_add_u32 m0, s69, 0
  s_nop 0
  buffer_load_dwordx4 v232, s[4:7], s70 offen lds
  s_branch L_C2

L_F:
  s_load_dwordx2 s[8:9], s[0:1], 8
  s_load_dwordx2 s[12:13], s[0:1], 16
  s_load_dwordx2 s[16:17], s[0:1], 24
  s_load_dwordx2 s[32:33], s[0:1], 72
  s_getpc_b64 s[20:21]
L_pc:
  s_lshl_b32 s63, s62, 13
  v_lshl_add_u32 v224, v0, 5, s63
  v_min_u32 v224, L_code_end-L_pc-4, v224
  global_load_dword v225, v224, s[20:21]
  s_lshl4_add_u32 s63, s2, s3
  s_cmp_eq_u32 s63, 32
  s_cbranch_scc1 L_init
L_noinit:
  s_mov_b32 s6, 2097152
  s_mov_b32 s7, 0x20000
  s_mov_b32 s10, 2097152
  s_mov_b32 s11, 0x20000
  s_mov_b32 s14, 2097152
  s_mov_b32 s15, 0x20000
  s_mov_b32 s18, 4096
  s_mov_b32 s19, 0x20000
  s_setprio 2
  v_and_b32 v1, 15, v255
  v_lshrrev_b32 v3, 4, v255
  s_lshr_b32 s62, s61, 1
  s_and_b32 s63, s61, 1
  s_lshl1_add_u32 s64, s56, s62
  s_lshl1_add_u32 s65, s57, s63
  s_lshl_b32 s73, s64, 15
  s_lshl_b32 s74, s65, 6
  s_add_u32 s73, s73, s74
  v_lshlrev_b32 v4, 13, v3
  v_lshl_add_u32 v4, v1, 2, v4
  v_add_u32 v226, s73, v4
  v_add_u32 v227, 4096, v226
  v_add_u32 v228, 0xfffff400, v226
  s_lshl_b32 s74, s65, 8
  v_lshl_add_u32 v229, v1, 4, s74
  v_and_b32 v200, 0x1f0, v252
  v_lshrrev_b32 v201, 5, v255
  v_lshl_add_u32 v200, v201, 10, v200
  s_lshl3_add_u32 s28, s56, s57
  s_lshl2_add_u32 s28, s28, s61
  s_lshl_b32 s29, s28, 11
  s_waitcnt lgkmcnt(0)
  buffer_load_dwordx4 v[120:123], v200, s[4:7], s29 offen
  buffer_load_dwordx4 v[124:127], v200, s[4:7], s29 offen offset:512
  s_cmp_eq_u32 s57, 3
  s_cbranch_scc1 L_F_notl
  buffer_load_dword v128, v228, s[8:11], 0 offen offset:0
  buffer_load_dword v129, v228, s[8:11], 0 offen offset:1024
  buffer_load_dword v130, v228, s[8:11], 0 offen offset:2048
  buffer_load_dwordx4 v[148:151], v229, s[16:19], 0 offen
  buffer_load_dword v131, v226, s[8:11], 0 offen offset:0
  buffer_load_dword v132, v226, s[8:11], 0 offen offset:1024
  buffer_load_dword v133, v226, s[8:11], 0 offen offset:2048
  buffer_load_dword v134, v226, s[8:11], 0 offen offset:3072
  buffer_load_dword v135, v227, s[8:11], 0 offen offset:0
  buffer_load_dword v136, v227, s[8:11], 0 offen offset:1024
  buffer_load_dword v137, v227, s[8:11], 0 offen offset:2048
  buffer_load_dword v138, v227, s[8:11], 0 offen offset:3072
  buffer_load_dword v140, v226, s[12:15], 0 offen offset:0
  buffer_load_dword v141, v226, s[12:15], 0 offen offset:1024
  buffer_load_dword v142, v226, s[12:15], 0 offen offset:2048
  buffer_load_dword v143, v226, s[12:15], 0 offen offset:3072
  buffer_load_dword v144, v227, s[12:15], 0 offen offset:0
  buffer_load_dword v145, v227, s[12:15], 0 offen offset:1024
  buffer_load_dword v146, v227, s[12:15], 0 offen offset:2048
  buffer_load_dword v147, v227, s[12:15], 0 offen offset:3072
L_F_notl:
  s_setprio 2
  s_branch L_F2

L_init:
  s_load_dwordx2 s[44:45], s[0:1], 96
  v_mov_b32 v4, 0
  v_mov_b32 v5, 0
  v_mov_b32 v6, 0
  v_mov_b32 v7, 0
  v_add_u32 v8, 0, v252
  v_add_u32 v9, 4096, v8
  s_waitcnt lgkmcnt(0)
  global_store_dwordx4 v8, v[4:7], s[48:49] offset:0 sc1
  global_store_dwordx4 v8, v[4:7], s[48:49] offset:1024 sc1
  global_store_dwordx4 v8, v[4:7], s[48:49] offset:2048 sc1
  global_store_dwordx4 v8, v[4:7], s[48:49] offset:3072 sc1
  global_store_dwordx4 v9, v[4:7], s[48:49] sc1
  s_mov_b32 s63, 1
  s_waitcnt vmcnt(0)
  s_atomic_add s63, s[44:45], 0
  s_waitcnt lgkmcnt(0)
  s_branch L_noinit
L_C_aux:
  s_load_dwordx2 s[28:29], s[0:1], 64
  s_load_dwordx2 s[44:45], s[0:1], 96
  s_mov_b32 s30, 3584
  s_mov_b32 s31, 0x20000
  s_mov_b32 s50, 16777216
  s_mov_b32 s51, 0x20000
  s_mov_b32 s46, 256
  s_mov_b32 s47, 0x20000
  v_mul_u32_u24 v16, 3584, v3
  v_lshl_add_u32 v16, v4, 4, v16
  s_waitcnt lgkmcnt(0)
  s_bitcmp1_b32 s2, 0
  s_cselect_b32 s66, 14, 0
  s_add_u32 s66, s66, s58
  s_mul_i32 s63, s61, 458752
  s_lshl_b32 s65, s66, 7
  s_add_u32 s63, s63, s65
  buffer_load_dwordx4 v[32:35], v16, s[24:27], s63 offen
  s_add_u32 s63, s63, 28672
  buffer_load_dwordx4 v[36:39], v16, s[24:27], s63 offen
  s_add_u32 s63, s63, 28672
  buffer_load_dwordx4 v[40:43], v16, s[24:27], s63 offen
  s_add_u32 s63, s63, 28672
  buffer_load_dwordx4 v[44:47], v16, s[24:27], s63 offen
  s_add_u32 s63, s63, 28672
  buffer_load_dwordx4 v[48:51], v16, s[24:27], s63 offen
  s_add_u32 s63, s63, 28672
  buffer_load_dwordx4 v[52:55], v16, s[24:27], s63 offen
  s_add_u32 s63, s63, 28672
  buffer_load_dwordx4 v[56:59], v16, s[24:27], s63 offen
  s_add_u32 s63, s63, 28672
  buffer_load_dwordx4 v[60:63], v16, s[24:27], s63 offen
  s_add_u32 s63, s63, 28672
  buffer_load_dwordx4 v[64:67], v16, s[24:27], s63 offen
  s_add_u32 s63, s63, 28672
  buffer_load_dwordx4 v[68:71], v16, s[24:27], s63 offen
  s_add_u32 s63, s63, 28672
  buffer_load_dwordx4 v[72:75], v16, s[24:27], s63 offen
  s_add_u32 s63, s63, 28672
  buffer_load_dwordx4 v[76:79], v16, s[24:27], s63 offen
  s_add_u32 s63, s63, 28672
  buffer_load_dwordx4 v[80:83], v16, s[24:27], s63 offen
  s_add_u32 s63, s63, 28672
  buffer_load_dwordx4 v[84:87], v16, s[24:27], s63 offen
  s_add_u32 s63, s63, 28672
  buffer_load_dwordx4 v[88:91], v16, s[24:27], s63 offen
  s_add_u32 s63, s63, 28672
  buffer_load_dwordx4 v[92:95], v16, s[24:27], s63 offen
  s_add_u32 s63, s63, 28672
  v_lshlrev_b32 v6, 1, v255
  buffer_load_ushort v30, v6, s[28:31], s65 offen
  s_barrier
  v_mov_b32 v16, 0x00003f80
  v_mov_b32 v17, 0x3f800000
  s_waitcnt vmcnt(16)
  v_dot2_f32_bf16 v100, v32, v16, 0
  v_dot2_f32_bf16 v101, v32, v17, 0
  v_dot2_f32_bf16 v102, v33, v16, 0
  v_dot2_f32_bf16 v103, v33, v17, 0
  v_dot2_f32_bf16 v104, v34, v16, 0
  v_dot2_f32_bf16 v105, v34, v17, 0
  v_dot2_f32_bf16 v106, v35, v16, 0
  v_dot2_f32_bf16 v107, v35, v17, 0
  s_waitcnt vmcnt(15)
  v_dot2_f32_bf16 v100, v36, v16, v100
  v_dot2_f32_bf16 v101, v36, v17, v101
  v_dot2_f32_bf16 v102, v37, v16, v102
  v_dot2_f32_bf16 v103, v37, v17, v103
  v_dot2_f32_bf16 v104, v38, v16, v104
  v_dot2_f32_bf16 v105, v38, v17, v105
  v_dot2_f32_bf16 v106, v39, v16, v106
  v_dot2_f32_bf16 v107, v39, v17, v107
  s_waitcnt vmcnt(14)
  v_dot2_f32_bf16 v100, v40, v16, v100
  v_dot2_f32_bf16 v101, v40, v17, v101
  v_dot2_f32_bf16 v102, v41, v16, v102
  v_dot2_f32_bf16 v103, v41, v17, v103
  v_dot2_f32_bf16 v104, v42, v16, v104
  v_dot2_f32_bf16 v105, v42, v17, v105
  v_dot2_f32_bf16 v106, v43, v16, v106
  v_dot2_f32_bf16 v107, v43, v17, v107
  s_waitcnt vmcnt(13)
  v_dot2_f32_bf16 v100, v44, v16, v100
  v_dot2_f32_bf16 v101, v44, v17, v101
  v_dot2_f32_bf16 v102, v45, v16, v102
  v_dot2_f32_bf16 v103, v45, v17, v103
  v_dot2_f32_bf16 v104, v46, v16, v104
  v_dot2_f32_bf16 v105, v46, v17, v105
  v_dot2_f32_bf16 v106, v47, v16, v106
  v_dot2_f32_bf16 v107, v47, v17, v107
  s_waitcnt vmcnt(12)
  v_dot2_f32_bf16 v100, v48, v16, v100
  v_dot2_f32_bf16 v101, v48, v17, v101
  v_dot2_f32_bf16 v102, v49, v16, v102
  v_dot2_f32_bf16 v103, v49, v17, v103
  v_dot2_f32_bf16 v104, v50, v16, v104
  v_dot2_f32_bf16 v105, v50, v17, v105
  v_dot2_f32_bf16 v106, v51, v16, v106
  v_dot2_f32_bf16 v107, v51, v17, v107
  s_waitcnt vmcnt(11)
  v_dot2_f32_bf16 v100, v52, v16, v100
  v_dot2_f32_bf16 v101, v52, v17, v101
  v_dot2_f32_bf16 v102, v53, v16, v102
  v_dot2_f32_bf16 v103, v53, v17, v103
  v_dot2_f32_bf16 v104, v54, v16, v104
  v_dot2_f32_bf16 v105, v54, v17, v105
  v_dot2_f32_bf16 v106, v55, v16, v106
  v_dot2_f32_bf16 v107, v55, v17, v107
  s_waitcnt vmcnt(10)
  v_dot2_f32_bf16 v100, v56, v16, v100
  v_dot2_f32_bf16 v101, v56, v17, v101
  v_dot2_f32_bf16 v102, v57, v16, v102
  v_dot2_f32_bf16 v103, v57, v17, v103
  v_dot2_f32_bf16 v104, v58, v16, v104
  v_dot2_f32_bf16 v105, v58, v17, v105
  v_dot2_f32_bf16 v106, v59, v16, v106
  v_dot2_f32_bf16 v107, v59, v17, v107
  s_waitcnt vmcnt(9)
  v_dot2_f32_bf16 v100, v60, v16, v100
  v_dot2_f32_bf16 v101, v60, v17, v101
  v_dot2_f32_bf16 v102, v61, v16, v102
  v_dot2_f32_bf16 v103, v61, v17, v103
  v_dot2_f32_bf16 v104, v62, v16, v104
  v_dot2_f32_bf16 v105, v62, v17, v105
  v_dot2_f32_bf16 v106, v63, v16, v106
  v_dot2_f32_bf16 v107, v63, v17, v107
  s_waitcnt vmcnt(8)
  v_dot2_f32_bf16 v100, v64, v16, v100
  v_dot2_f32_bf16 v101, v64, v17, v101
  v_dot2_f32_bf16 v102, v65, v16, v102
  v_dot2_f32_bf16 v103, v65, v17, v103
  v_dot2_f32_bf16 v104, v66, v16, v104
  v_dot2_f32_bf16 v105, v66, v17, v105
  v_dot2_f32_bf16 v106, v67, v16, v106
  v_dot2_f32_bf16 v107, v67, v17, v107
  s_waitcnt vmcnt(7)
  v_dot2_f32_bf16 v100, v68, v16, v100
  v_dot2_f32_bf16 v101, v68, v17, v101
  v_dot2_f32_bf16 v102, v69, v16, v102
  v_dot2_f32_bf16 v103, v69, v17, v103
  v_dot2_f32_bf16 v104, v70, v16, v104
  v_dot2_f32_bf16 v105, v70, v17, v105
  v_dot2_f32_bf16 v106, v71, v16, v106
  v_dot2_f32_bf16 v107, v71, v17, v107
  s_cmp_lg_u32 s61, 0
  s_cbranch_scc1 L_nDa
  s_load_dword s12, s[44:45], 0
L_nDa:
  s_waitcnt vmcnt(6)
  v_dot2_f32_bf16 v100, v72, v16, v100
  v_dot2_f32_bf16 v101, v72, v17, v101
  v_dot2_f32_bf16 v102, v73, v16, v102
  v_dot2_f32_bf16 v103, v73, v17, v103
  v_dot2_f32_bf16 v104, v74, v16, v104
  v_dot2_f32_bf16 v105, v74, v17, v105
  v_dot2_f32_bf16 v106, v75, v16, v106
  v_dot2_f32_bf16 v107, v75, v17, v107
  s_waitcnt vmcnt(5)
  v_dot2_f32_bf16 v100, v76, v16, v100
  v_dot2_f32_bf16 v101, v76, v17, v101
  v_dot2_f32_bf16 v102, v77, v16, v102
  v_dot2_f32_bf16 v103, v77, v17, v103
  v_dot2_f32_bf16 v104, v78, v16, v104
  v_dot2_f32_bf16 v105, v78, v17, v105
  v_dot2_f32_bf16 v106, v79, v16, v106
  v_dot2_f32_bf16 v107, v79, v17, v107
  s_waitcnt vmcnt(4)
  v_dot2_f32_bf16 v100, v80, v16, v100
  v_dot2_f32_bf16 v101, v80, v17, v101
  v_dot2_f32_bf16 v102, v81, v16, v102
  v_dot2_f32_bf16 v103, v81, v17, v103
  v_dot2_f32_bf16 v104, v82, v16, v104
  v_dot2_f32_bf16 v105, v82, v17, v105
  v_dot2_f32_bf16 v106, v83, v16, v106
  v_dot2_f32_bf16 v107, v83, v17, v107
  s_waitcnt vmcnt(3)
  v_dot2_f32_bf16 v100, v84, v16, v100
  v_dot2_f32_bf16 v101, v84, v17, v101
  v_dot2_f32_bf16 v102, v85, v16, v102
  v_dot2_f32_bf16 v103, v85, v17, v103
  v_dot2_f32_bf16 v104, v86, v16, v104
  v_dot2_f32_bf16 v105, v86, v17, v105
  v_dot2_f32_bf16 v106, v87, v16, v106
  v_dot2_f32_bf16 v107, v87, v17, v107
  s_waitcnt vmcnt(2)
  v_dot2_f32_bf16 v100, v88, v16, v100
  v_dot2_f32_bf16 v101, v88, v17, v101
  v_dot2_f32_bf16 v102, v89, v16, v102
  v_dot2_f32_bf16 v103, v89, v17, v103
  v_dot2_f32_bf16 v104, v90, v16, v104
  v_dot2_f32_bf16 v105, v90, v17, v105
  v_dot2_f32_bf16 v106, v91, v16, v106
  v_dot2_f32_bf16 v107, v91, v17, v107
  s_waitcnt vmcnt(1)
  v_dot2_f32_bf16 v100, v92, v16, v100
  v_dot2_f32_bf16 v101, v92, v17, v101
  v_dot2_f32_bf16 v102, v93, v16, v102
  v_dot2_f32_bf16 v103, v93, v17, v103
  v_dot2_f32_bf16 v104, v94, v16, v104
  v_dot2_f32_bf16 v105, v94, v17, v105
  v_dot2_f32_bf16 v106, v95, v16, v106
  v_dot2_f32_bf16 v107, v95, v17, v107
  s_lshl_b32 s63, s61, 11
  v_lshl_add_u32 v6, v255, 5, s63
  ds_write_b128 v6, v[100:103]
  ds_write_b128 v6, v[104:107] offset:16
  s_cmp_lg_u32 s61, 0
  s_cbranch_scc1 L_pollDa_ok
  s_mov_b32 s72, 0
L_pollDa:
  s_waitcnt lgkmcnt(0)
  s_cmp_ge_u32 s12, 1
  s_cbranch_scc1 L_pollDa_ok
L_pollDa_re:
  s_add_u32 s72, s72, 1
  s_cmp_ge_u32 s72, 50000
  s_cbranch_scc1 L_pollDa_ok
  s_sleep 8
  buffer_load_dword v24, v254, s[44:47], 0 offen sc1
  s_waitcnt vmcnt(0)
  v_readfirstlane_b32 s12, v24
  s_branch L_pollDa
L_pollDa_ok:
  s_waitcnt lgkmcnt(0)
  s_barrier
  s_cmp_lg_u32 s61, 3
  s_cbranch_scc1 L_nocs
  s_cmp_ge_u32 s58, 14
  s_cbranch_scc1 L_nocs
  v_lshlrev_b32 v6, 2, v255
  ds_read_b32 v32, v6 offset:0
  ds_read_b32 v33, v6 offset:256
  ds_read_b32 v34, v6 offset:512
  ds_read_b32 v35, v6 offset:768
  ds_read_b32 v36, v6 offset:1024
  ds_read_b32 v37, v6 offset:1280
  ds_read_b32 v38, v6 offset:1536
  ds_read_b32 v39, v6 offset:1792
  ds_read_b32 v40, v6 offset:2048
  ds_read_b32 v41, v6 offset:2304
  ds_read_b32 v42, v6 offset:2560
  ds_read_b32 v43, v6 offset:2816
  ds_read_b32 v44, v6 offset:3072
  ds_read_b32 v45, v6 offset:3328
  ds_read_b32 v46, v6 offset:3584
  ds_read_b32 v47, v6 offset:3840
  ds_read_b32 v48, v6 offset:4096
  ds_read_b32 v49, v6 offset:4352
  ds_read_b32 v50, v6 offset:4608
  ds_read_b32 v51, v6 offset:4864
  ds_read_b32 v52, v6 offset:5120
  ds_read_b32 v53, v6 offset:5376
  ds_read_b32 v54, v6 offset:5632
  ds_read_b32 v55, v6 offset:5888
  ds_read_b32 v56, v6 offset:6144
  ds_read_b32 v57, v6 offset:6400
  ds_read_b32 v58, v6 offset:6656
  ds_read_b32 v59, v6 offset:6912
  ds_read_b32 v60, v6 offset:7168
  ds_read_b32 v61, v6 offset:7424
  ds_read_b32 v62, v6 offset:7680
  ds_read_b32 v63, v6 offset:7936
  s_waitcnt lgkmcnt(15)
  v_add_f32 v32, v32, v48
  s_waitcnt lgkmcnt(14)
  v_add_f32 v33, v33, v49
  s_waitcnt lgkmcnt(13)
  v_add_f32 v34, v34, v50
  s_waitcnt lgkmcnt(12)
  v_add_f32 v35, v35, v51
  s_waitcnt lgkmcnt(11)
  v_add_f32 v36, v36, v52
  s_waitcnt lgkmcnt(10)
  v_add_f32 v37, v37, v53
  s_waitcnt lgkmcnt(9)
  v_add_f32 v38, v38, v54
  s_waitcnt lgkmcnt(8)
  v_add_f32 v39, v39, v55
  s_waitcnt lgkmcnt(7)
  v_add_f32 v40, v40, v56
  s_waitcnt lgkmcnt(6)
  v_add_f32 v41, v41, v57
  s_waitcnt lgkmcnt(5)
  v_add_f32 v42, v42, v58
  s_waitcnt lgkmcnt(4)
  v_add_f32 v43, v43, v59
  s_waitcnt lgkmcnt(3)
  v_add_f32 v44, v44, v60
  s_waitcnt lgkmcnt(2)
  v_add_f32 v45, v45, v61
  s_waitcnt lgkmcnt(1)
  v_add_f32 v46, v46, v62
  s_waitcnt lgkmcnt(0)
  v_add_f32 v47, v47, v63
  v_add_f32 v32, v32, v40
  v_add_f32 v33, v33, v41
  v_add_f32 v34, v34, v42
  v_add_f32 v35, v35, v43
  v_add_f32 v36, v36, v44
  v_add_f32 v37, v37, v45
  v_add_f32 v38, v38, v46
  v_add_f32 v39, v39, v47
  v_add_f32 v32, v32, v36
  v_add_f32 v33, v33, v37
  v_add_f32 v34, v34, v38
  v_add_f32 v35, v35, v39
  v_add_f32 v32, v32, v34
  v_add_f32 v33, v33, v35
  v_add_f32 v32, v32, v33
  s_waitcnt vmcnt(0)
  v_lshlrev_b32 v30, 16, v30
  v_cvt_pk_bf16_f32 v33, v32, v32
  v_lshlrev_b32 v33, 16, v33
  v_sub_f32 v34, v32, v33
  v_cvt_pk_bf16_f32 v36, v33, v34
  v_and_b32 v35, 0xffff0000, v36
  v_sub_f32 v34, v34, v35
  v_cvt_pk_bf16_f32 v37, v34, v30
  v_lshlrev_b32 v6, 3, v255
  s_lshr_b32 s63, s66, 1
  s_lshl_b32 s65, s66, 9
  s_add_u32 s65, s65, 65536
  buffer_store_dwordx2 v[36:37], v6, s[48:51], s65 offen sc1
  s_add_u32 s63, s63, 24
  s_lshl_b32 s63, s63, 7
  s_barrier
  s_waitcnt vmcnt(0)
  s_mov_b32 s18, 1
  s_atomic_add s18, s[48:49], s63
  s_branch L_cs2
L_nocs:
  s_lshr_b32 s63, s56, 1
  s_add_u32 s63, s63, 8
  s_lshl_b32 s19, s63, 7
  s_cmp_lg_u32 s61, 0
  s_cbranch_scc1 L_sigSa
  s_mov_b32 s17, 4
  s_atomic_add s17, s[48:49], s19
L_sigSa:
  s_barrier
L_cs2:
  s_load_dwordx2 s[44:45], s[0:1], 96
  s_load_dwordx2 s[20:21], s[0:1], 32
  s_load_dwordx2 s[32:33], s[0:1], 72
  s_load_dwordx2 s[36:37], s[0:1], 80
  s_load_dwordx2 s[40:41], s[0:1], 88
  s_load_dwordx2 s[52:53], s[0:1], 40
  s_mov_b32 s50, 16777216
  s_mov_b32 s51, 0x20000
  s_mov_b32 s46, 256
  s_mov_b32 s47, 0x20000
  s_mov_b32 s22, 2097152
  s_mov_b32 s23, 0x20000
  s_mov_b32 s38, 1024
  s_mov_b32 s39, 0x20000
  s_bfe_u32 s79, s55, 0x10002
  s_lshl1_add_u32 s79, s58, s79
  s_lshr_b32 s31, s55, 3
  s_xor_b32 s31, s31, 3
  s_and_b32 s3, s2, 1
  s_lshl2_add_u32 s31, s3, s31
  s_lshr_b32 s3, s54, 1
  s_lshl1_add_u32 s3, s55, s3
  v_lshrrev_b32 v1, 5, v255
  s_lshr_b32 s63, s55, 3
  s_lshl2_add_u32 s63, s54, s63
  s_lshr_b32 s64, s61, 1
  s_lshl1_add_u32 s63, s63, s64
  s_and_b32 s64, s55, 7
  s_lshl3_add_u32 s60, s63, s64
  s_lshr_b32 s63, s56, 1
  s_add_u32 s63, s63, 8
  s_lshl_b32 s8, s63, 7
  s_lshl_b32 s16, s57, 7
  v_bfe_u32 v6, v255, 2, 1
  v_bfe_u32 v7, v255, 3, 1
  v_and_b32 v16, 1, v5
  v_xor_b32 v16, v16, v6
  v_xor_b32 v16, v16, v7
  v_lshl_add_u32 v6, v16, 1, v6
  v_lshl_add_u32 v17, v7, 2, v6
  s_and_b32 s63, s61, 1
  s_lshl_b32 s63, s63, 3
  v_lshl_add_u32 v247, v1, 4, v17
  v_add_u32 v247, s63, v247
  s_and_b32 s63, s60, -2
  s_lshl_b32 s63, s63, 1
  s_waitcnt lgkmcnt(0)
  s_load_dword s68, s[52:53], s63
  s_lshl_b32 s63, s60, 12
  s_and_b32 s64, s61, 1
  s_mul_i32 s65, s61, 4144
  s_lshl2_add_u32 s64, s64, s65
  s_add_u32 m0, s64, 131104
  s_nop 0
  buffer_load_dwordx4 v252, s[20:23], s63 offen offset:0 lds
  buffer_load_dwordx4 v252, s[20:23], s63 offen offset:1024 lds
  buffer_load_dwordx4 v252, s[20:23], s63 offen offset:2048 lds
  buffer_load_dwordx4 v252, s[20:23], s63 offen offset:3072 lds
  s_lshr_b32 s64, s61, 1
  s_lshl1_add_u32 s63, s31, s64
  s_lshl_b32 s63, s63, 6
  s_lshl_b32 s30, s79, 16
  s_add_u32 s30, s30, s63
  v_and_b32 v186, 48, v252
  buffer_load_dwordx4 v[228:231], v186, s[36:39], s63 offen
  s_and_b32 s63, s79, 1
  s_lshl_b32 s63, s63, 6
  v_add_u32 v20, s63, v247
  v_bfe_u32 v21, v20, 1, 3
  v_and_b32 v22, 3, v255
  v_lshl_add_u32 v22, s64, 2, v22
  v_xor_b32 v21, v21, v22
  v_lshlrev_b32 v21, 4, v21
  v_lshl_add_u32 v244, v20, 7, v21
  v_add_u32 v245, 0x10000, v244
  v_mov_b32 v21, 156928
  v_lshl_add_u32 v187, v20, 4, v21
  v_lshl_add_u32 v248, v247, 10, v186
  s_add_u32 s63, s30, 32768
  buffer_load_dwordx4 v[216:219], v248, s[4:7], s30 offen
  buffer_load_dwordx4 v[220:223], v248, s[4:7], s63 offen
  s_lshr_b32 s28, s61, 1
  s_and_b32 s15, s61, 1
  s_lshl3_add_u32 s28, s28, s15
  s_lshl_b32 s28, s28, 12
  s_add_u32 s28, s28, 90112
  s_xor_b32 s29, s28, 4096
  s_mov_b32 s34, 1835008
  s_mov_b32 s35, 0x20000
  s_add_u32 s78, s58, 8
  s_lshl_b32 s9, s78, 7
  s_add_u32 s78, s59, 24
  s_lshl_b32 s10, s78, 7
  s_lshl_b32 s11, s54, 7
  s_lshl_b32 s18, s31, 7
  v_lshlrev_b32 v6, 1, v5
  v_xor_b32 v6, v6, v4
  v_lshlrev_b32 v6, 4, v6
  v_lshl_add_u32 v6, v3, 10, v6
  s_lshl_b32 s15, s61, 13
  s_lshl_b32 s78, s31, 7
  s_add_u32 s15, s15, s78
  v_add_u32 v240, s15, v6
  s_add_u32 s15, s3, 0
  s_and_b32 s15, s15, 3
  s_mul_i32 s73, s15, 458752
  s_add_u32 s15, s3, 1
  s_and_b32 s15, s15, 3
  s_mul_i32 s74, s15, 458752
  s_add_u32 s15, s3, 2
  s_and_b32 s15, s15, 3
  s_mul_i32 s75, s15, 458752
  s_add_u32 s15, s3, 3
  s_and_b32 s15, s15, 3
  s_mul_i32 s76, s15, 458752
  v_xor_b32 v6, v5, v4
  v_lshlrev_b32 v6, 4, v6
  v_lshl_add_u32 v243, v3, 7, v6
  v_xor_b32 v242, 64, v243
  v_bfe_u32 v6, v255, 2, 2
  v_and_b32 v7, 3, v255
  v_sub_u32 v6, v7, v6
  v_lshlrev_b32 v6, 3, v6
  v_lshlrev_b32 v7, 6, v5
  v_sub_u32 v6, v6, v7
  s_and_b32 s15, s61, 2
  s_mul_i32 s78, s15, 4144
  s_add_u32 s78, s78, 131296
  v_add_u32 v200, s78, v6
  v_add_u32 v201, 4144, v200
  v_and_b32 v6, 15, v255
  v_lshl_add_u32 v7, v5, 1, v6
  s_lshl_b32 s15, s15, 1
  s_and_b32 s78, s61, 1
  s_add_u32 s78, s78, s15
  v_add_u32 v16, 1, v7
  v_and_b32 v18, 1, v16
  v_lshlrev_b32 v18, 3, v18
  v_lshrrev_b32 v19, 1, v16
  v_lshl_add_u32 v18, v19, 7, v18
  v_add_u32 v18, 147712, v18
  v_lshrrev_b32 v16, 2, v16
  v_and_b32 v17, 7, v16
  v_xor_b32 v17, s78, v17
  v_lshl_add_u32 v202, v17, 4, v18
  v_xor_b32 v206, 64, v202
  v_add_u32 v16, 2, v16
  v_and_b32 v17, 7, v16
  v_xor_b32 v17, s78, v17
  v_lshl_add_u32 v204, v17, 4, v18
  v_xor_b32 v208, 64, v204
  v_add_u32 v16, 2, v7
  v_and_b32 v18, 1, v16
  v_lshlrev_b32 v18, 3, v18
  v_lshrrev_b32 v19, 1, v16
  v_lshl_add_u32 v18, v19, 7, v18
  v_add_u32 v18, 147712, v18
  v_lshrrev_b32 v16, 2, v16
  v_and_b32 v17, 7, v16
  v_xor_b32 v17, s78, v17
  v_lshl_add_u32 v203, v17, 4, v18
  v_xor_b32 v207, 64, v203
  v_add_u32 v16, 2, v16
  v_and_b32 v17, 7, v16
  v_xor_b32 v17, s78, v17
  v_lshl_add_u32 v205, v17, 4, v18
  v_xor_b32 v209, 64, v205
  v_lshl_add_u32 v16, v6, 2, v5
  v_lshrrev_b32 v17, 4, v16
  v_add_u32 v17, 4, v17
  v_xor_b32 v17, s15, v17
  v_lshlrev_b32 v17, 4, v17
  v_and_b32 v18, 7, v16
  v_lshl_add_u32 v17, v18, 1, v17
  v_lshrrev_b32 v16, 3, v16
  v_lshl_add_u32 v17, v16, 7, v17
  s_and_b32 s78, s61, 1
  s_lshl_b32 s78, s78, 12
  s_add_u32 s78, s78, 148736
  v_add_u32 v210, s78, v17
  v_and_b32 v16, 3, v6
  v_lshlrev_b32 v16, 4, v16
  v_lshrrev_b32 v17, 2, v6
  v_lshl_add_u32 v16, v17, 7, v16
  v_lshl_add_u32 v16, v1, 6, v16
  v_and_b32 v17, 1, v5
  v_lshl_add_u32 v211, v17, 9, v16
  v_add_u32 v16, -16, v255
  v_add_u32 v17, -1, v255
  v_and_b32 v17, 15, v17
  v_cmp_gt_u32 vcc, 16, v255
  v_add_u32 v17, 48, v17
  s_nop 0
  v_cndmask_b32 v16, v16, v17, vcc
  v_lshlrev_b32 v212, 2, v16
  v_add_u32 v213, s28, v252
  v_add_u32 v214, s29, v252
  v_xor_b32 v176, 0, v210
  v_xor_b32 v177, 16, v210
  v_xor_b32 v178, 32, v210
  v_xor_b32 v179, 48, v210
  v_xor_b32 v180, 64, v210
  v_xor_b32 v181, 80, v210
  v_xor_b32 v182, 96, v210
  v_xor_b32 v183, 112, v210
  s_lshl2_add_u32 s15, s61, 160000
  v_mov_b32 v184, s15
  v_xor_b32 v185, 4, v184
  s_barrier
  s_cmp_lg_u32 s61, 1
  s_cbranch_scc1 L_sigTa
  s_mov_b32 s17, 1
  s_atomic_add s17, s[48:49], s16
L_sigTa:
  s_add_u32 m0, s69, 0
  s_add_u32 s65, s73, 0
  buffer_load_dwordx4 v240, s[32:35], s65 offen lds
  s_add_u32 m0, s69, 4096
  s_add_u32 s65, s73, 65536
  buffer_load_dwordx4 v240, s[32:35], s65 offen lds
  s_add_u32 m0, s69, 8192
  s_add_u32 s65, s73, 131072
  buffer_load_dwordx4 v240, s[32:35], s65 offen lds
  s_add_u32 m0, s69, 12288
  s_add_u32 s65, s73, 196608
  buffer_load_dwordx4 v240, s[32:35], s65 offen lds
  s_add_u32 m0, s69, 16384
  s_add_u32 s65, s74, 0
  buffer_load_dwordx4 v240, s[32:35], s65 offen lds
  s_add_u32 m0, s69, 20480
  s_add_u32 s65, s74, 65536
  buffer_load_dwordx4 v240, s[32:35], s65 offen lds
  s_add_u32 m0, s69, 24576
  s_add_u32 s65, s74, 131072
  buffer_load_dwordx4 v240, s[32:35], s65 offen lds
  s_add_u32 m0, s69, 28672
  s_add_u32 s65, s74, 196608
  buffer_load_dwordx4 v240, s[32:35], s65 offen lds
  s_add_u32 m0, s69, 32768
  s_add_u32 s65, s75, 0
  buffer_load_dwordx4 v240, s[32:35], s65 offen lds
  s_add_u32 m0, s69, 36864
  s_add_u32 s65, s75, 65536
  buffer_load_dwordx4 v240, s[32:35], s65 offen lds
  s_add_u32 m0, s69, 40960
  s_add_u32 s65, s75, 131072
  buffer_load_dwordx4 v240, s[32:35], s65 offen lds
  s_add_u32 m0, s69, 45056
  s_add_u32 s65, s75, 196608
  buffer_load_dwordx4 v240, s[32:35], s65 offen lds
  s_add_u32 m0, s69, 49152
  s_add_u32 s65, s76, 0
  buffer_load_dwordx4 v240, s[32:35], s65 offen lds
  s_add_u32 m0, s69, 53248
  s_add_u32 s65, s76, 65536
  buffer_load_dwordx4 v240, s[32:35], s65 offen lds
  s_waitcnt vmcnt(17)
  s_cmp_lg_u32 s61, 2
  s_cbranch_scc1 L_n1a
  s_load_dword s12, s[48:49], s9
  s_mov_b32 s72, 0
L_poll1a:
  s_waitcnt lgkmcnt(0)
  s_cmp_ge_u32 s12, 64
  s_cbranch_scc1 L_poll1a_ok
L_poll1a_re:
  s_add_u32 s72, s72, 1
  s_cmp_ge_u32 s72, 50000
  s_cbranch_scc1 L_poll1a_ok
  s_sleep 16
  buffer_load_dword v24, v254, s[48:51], s9 offen sc1
  s_waitcnt vmcnt(0)
  v_readfirstlane_b32 s12, v24
  s_branch L_poll1a
L_poll1a_ok:
  s_lshl_b32 s63, s58, 11
  s_add_u32 s63, s63, 32768
  s_lshl_b32 s64, s59, 10
  s_mov_b32 m0, 156928
  s_add_u32 s64, s64, 63488
  buffer_load_dwordx4 v252, s[48:51], s63 offen sc1 lds
  buffer_load_dwordx4 v252, s[48:51], s63 offen offset:1024 sc1 lds
L_n1a:
  s_branch L_C_join
L_F_aux:
  s_lshl1_add_u32 s64, s58, s62
  s_lshl1_add_u32 s65, s59, s63
  s_mul_i32 s73, s64, 229376
  s_lshl_b32 s75, s65, 13
  s_add_u32 s73, s73, s75
  s_add_u32 s73, s73, 5242880
  s_mul_i32 s75, s65, 37
  s_lshr_b32 s75, s75, 8
  s_lshl2_add_u32 s74, s64, s75
  s_add_u32 s74, s74, 128
  s_lshl_b32 s74, s74, 7
  s_add_u32 s62, s61, s3
  s_and_b32 s62, s62, 3
  s_mul_i32 s75, s62, 3584
  s_add_u32 s75, s75, s31
  s_add_u32 s75, s75, 256
  s_lshl_b32 s75, s75, 7
  s_lshl2_add_u32 s62, s79, s62
  s_mul_i32 s76, s62, 57344
  s_add_u32 s76, s76, 5242880
  s_add_u32 s77, s76, 4096
  s_add_u32 s62, s62, 128
  s_lshl_b32 s68, s62, 7
  s_add_u32 s66, s68, 16
  s_mov_b32 s64, 0x05040100
  s_mov_b32 s65, 0x07060302
  s_setprio 0
  s_waitcnt vmcnt(0)
  v_mov_b32 v202, 0x3f803f80
  v_dot2_f32_bf16 v204, v120, v202, 0
  v_dot2_f32_bf16 v205, v120, v120, 0
  v_dot2_f32_bf16 v204, v121, v202, v204
  v_dot2_f32_bf16 v205, v121, v121, v205
  v_dot2_f32_bf16 v204, v122, v202, v204
  v_dot2_f32_bf16 v205, v122, v122, v205
  v_dot2_f32_bf16 v204, v123, v202, v204
  v_dot2_f32_bf16 v205, v123, v123, v205
  v_dot2_f32_bf16 v204, v124, v202, v204
  v_dot2_f32_bf16 v205, v124, v124, v205
  v_dot2_f32_bf16 v204, v125, v202, v204
  v_dot2_f32_bf16 v205, v125, v125, v205
  v_dot2_f32_bf16 v204, v126, v202, v204
  v_dot2_f32_bf16 v205, v126, v126, v205
  v_dot2_f32_bf16 v204, v127, v202, v204
  v_dot2_f32_bf16 v205, v127, v127, v205
  s_nop 1
  v_add_f32_dpp v204, v204, v204 row_ror:8 row_mask:0xf bank_mask:0xf
  v_add_f32_dpp v205, v205, v205 row_ror:8 row_mask:0xf bank_mask:0xf
  s_nop 0
  v_add_f32_dpp v204, v204, v204 row_ror:4 row_mask:0xf bank_mask:0xf
  v_add_f32_dpp v205, v205, v205 row_ror:4 row_mask:0xf bank_mask:0xf
  s_nop 0
  v_add_f32_dpp v204, v204, v204 row_ror:2 row_mask:0xf bank_mask:0xf
  v_add_f32_dpp v205, v205, v205 row_ror:2 row_mask:0xf bank_mask:0xf
  s_nop 0
  v_add_f32_dpp v204, v204, v204 row_ror:1 row_mask:0xf bank_mask:0xf
  v_add_f32_dpp v205, v205, v205 row_ror:1 row_mask:0xf bank_mask:0xf
  v_mov_b32 v206, v204
  v_mov_b32 v207, v205
  s_nop 0
  v_permlane16_swap_b32 v204, v206
  v_permlane16_swap_b32 v205, v207
  v_add_f32 v204, v204, v206
  v_add_f32 v205, v205, v207
  v_mul_f32 v204, 0x3b000000, v204
  v_mul_f32 v205, 0x3b000000, v205
  v_fma_f32 v205, -v204, v204, v205
  v_max_f32 v205, 0, v205
  v_cvt_pk_bf16_f32 v204, v204, v205
  v_and_b32 v205, 0xffff0000, v204
  v_lshlrev_b32 v204, 16, v204
  v_add_f32 v205, 0x3727c5ac, v205
  v_cvt_pk_bf16_f32 v205, v205, v205
  v_lshlrev_b32 v205, 16, v205
  v_sqrt_f32 v205, v205
  s_nop 0
  v_cvt_pk_bf16_f32 v205, v205, v205
  v_lshlrev_b32 v205, 16, v205
  v_rcp_f32 v206, v205
  v_cvt_pk_bf16_f32 v220, -v204, -v204
  v_cvt_pk_bf16_f32 v221, -v204, v205
  v_mul_f32 v222, 0xc0135761, v206
  v_mul_f32 v207, v206, v206
  v_mul_f32 v207, 0x3d372713, v207
  v_mul_f32 v223, v222, v207
  s_mov_b32 exec_lo, 1
  s_mov_b32 exec_hi, 1
  buffer_store_dwordx4 v[220:223], v235, s[48:51], s28 offen sc1
  s_mov_b64 exec, 3
  buffer_store_dword v254, v252, s[48:51], s29 offen sc1
  s_mov_b64 exec, -1
  s_barrier
  buffer_load_dword v128, v228, s[8:11], 0 offen offset:0
  buffer_load_dword v129, v228, s[8:11], 0 offen offset:1024
  buffer_load_dword v130, v228, s[8:11], 0 offen offset:2048
  buffer_load_dwordx4 v[148:151], v229, s[16:19], 0 offen
  buffer_load_dword v131, v226, s[8:11], 0 offen offset:0
  buffer_load_dword v132, v226, s[8:11], 0 offen offset:1024
  buffer_load_dword v133, v226, s[8:11], 0 offen offset:2048
  buffer_load_dword v134, v226, s[8:11], 0 offen offset:3072
  buffer_load_dword v135, v227, s[8:11], 0 offen offset:0
  buffer_load_dword v136, v227, s[8:11], 0 offen offset:1024
  buffer_load_dword v137, v227, s[8:11], 0 offen offset:2048
  buffer_load_dword v138, v227, s[8:11], 0 offen offset:3072
  buffer_load_dword v140, v226, s[12:15], 0 offen offset:0
  buffer_load_dword v141, v226, s[12:15], 0 offen offset:1024
  buffer_load_dword v142, v226, s[12:15], 0 offen offset:2048
  buffer_load_dword v143, v226, s[12:15], 0 offen offset:3072
  buffer_load_dword v144, v227, s[12:15], 0 offen offset:0
  buffer_load_dword v145, v227, s[12:15], 0 offen offset:1024
  buffer_load_dword v146, v227, s[12:15], 0 offen offset:2048
  buffer_load_dword v147, v227, s[12:15], 0 offen offset:3072
  s_waitcnt vmcnt(20)
  s_barrier
  s_barrier
  s_waitcnt vmcnt(18)
  v_perm_b32 v152, v128, v129, s64
  v_perm_b32 v153, v128, v129, s65
  s_waitcnt vmcnt(17)
  v_perm_b32 v154, v129, v130, s64
  v_perm_b32 v155, v129, v130, s65
  s_waitcnt vmcnt(15)
  v_perm_b32 v156, v130, v131, s64
  v_perm_b32 v157, v130, v131, s65
  s_waitcnt vmcnt(14)
  v_perm_b32 v158, v131, v132, s64
  v_perm_b32 v159, v131, v132, s65
  s_waitcnt vmcnt(13)
  v_perm_b32 v160, v132, v133, s64
  v_perm_b32 v161, v132, v133, s65
  s_waitcnt vmcnt(12)
  v_perm_b32 v162, v133, v134, s64
  v_perm_b32 v163, v133, v134, s65
  s_waitcnt vmcnt(11)
  v_perm_b32 v164, v134, v135, s64
  v_perm_b32 v165, v134, v135, s65
  s_waitcnt vmcnt(10)
  v_perm_b32 v166, v135, v136, s64
  v_perm_b32 v167, v135, v136, s65
  s_waitcnt vmcnt(9)
  v_perm_b32 v168, v136, v137, s64
  v_perm_b32 v169, v136, v137, s65
  s_waitcnt vmcnt(8)
  v_perm_b32 v170, v137, v138, s64
  v_perm_b32 v171, v137, v138, s65
  v_dot2_f32_bf16 v172, v152, v149, 0
  v_dot2_f32_bf16 v173, v153, v151, 0
  v_dot2_f32_bf16 v174, v154, v149, 0
  v_dot2_f32_bf16 v175, v155, v151, 0
  v_dot2_f32_bf16 v176, v156, v149, 0
  v_dot2_f32_bf16 v177, v157, v151, 0
  v_dot2_f32_bf16 v178, v158, v149, 0
  v_dot2_f32_bf16 v179, v159, v151, 0
  v_dot2_f32_bf16 v180, v160, v149, 0
  v_dot2_f32_bf16 v181, v161, v151, 0
  v_dot2_f32_bf16 v182, v162, v149, 0
  v_dot2_f32_bf16 v183, v163, v151, 0
  v_dot2_f32_bf16 v184, v164, v149, 0
  v_dot2_f32_bf16 v185, v165, v151, 0
  v_dot2_f32_bf16 v186, v166, v149, 0
  v_dot2_f32_bf16 v187, v167, v151, 0
  v_dot2_f32_bf16 v172, v156, v148, v172
  v_dot2_f32_bf16 v173, v157, v150, v173
  v_dot2_f32_bf16 v174, v158, v148, v174
  v_dot2_f32_bf16 v175, v159, v150, v175
  v_dot2_f32_bf16 v176, v160, v148, v176
  v_dot2_f32_bf16 v177, v161, v150, v177
  v_dot2_f32_bf16 v178, v162, v148, v178
  v_dot2_f32_bf16 v179, v163, v150, v179
  v_dot2_f32_bf16 v180, v164, v148, v180
  v_dot2_f32_bf16 v181, v165, v150, v181
  v_dot2_f32_bf16 v182, v166, v148, v182
  v_dot2_f32_bf16 v183, v167, v150, v183
  v_dot2_f32_bf16 v184, v168, v148, v184
  v_dot2_f32_bf16 v185, v169, v150, v185
  v_dot2_f32_bf16 v186, v170, v148, v186
  v_dot2_f32_bf16 v187, v171, v150, v187
  s_waitcnt vmcnt(7)
  v_lshlrev_b32 v188, 16, v140
  v_and_b32 v189, 0xffff0000, v140
  s_waitcnt vmcnt(6)
  v_lshlrev_b32 v190, 16, v141
  v_and_b32 v191, 0xffff0000, v141
  s_waitcnt vmcnt(5)
  v_lshlrev_b32 v192, 16, v142
  v_and_b32 v193, 0xffff0000, v142
  s_waitcnt vmcnt(4)
  v_lshlrev_b32 v194, 16, v143
  v_and_b32 v195, 0xffff0000, v143
  s_waitcnt vmcnt(3)
  v_lshlrev_b32 v196, 16, v144
  v_and_b32 v197, 0xffff0000, v144
  s_waitcnt vmcnt(2)
  v_lshlrev_b32 v198, 16, v145
  v_and_b32 v199, 0xffff0000, v145
  s_waitcnt vmcnt(1)
  v_lshlrev_b32 v200, 16, v146
  v_and_b32 v201, 0xffff0000, v146
  s_waitcnt vmcnt(0)
  v_lshlrev_b32 v202, 16, v147
  v_and_b32 v203, 0xffff0000, v147
  v_pk_mul_f32 v[188:189], v[188:189], v[172:173]
  v_pk_mul_f32 v[190:191], v[190:191], v[174:175]
  v_pk_mul_f32 v[192:193], v[192:193], v[176:177]
  v_pk_mul_f32 v[194:195], v[194:195], v[178:179]
  v_pk_mul_f32 v[196:197], v[196:197], v[180:181]
  v_pk_mul_f32 v[198:199], v[198:199], v[182:183]
  v_pk_mul_f32 v[200:201], v[200:201], v[184:185]
  v_pk_mul_f32 v[202:203], v[202:203], v[186:187]
  s_mov_b32 vcc_lo, 0x55555555
  s_mov_b32 vcc_hi, 0x55555555
  v_cvt_pk_bf16_f32 v204, v188, v196
  v_cvt_pk_bf16_f32 v205, v190, v198
  v_cvt_pk_bf16_f32 v206, v192, v200
  v_cvt_pk_bf16_f32 v207, v194, v202
  v_cvt_pk_bf16_f32 v208, v189, v197
  v_cvt_pk_bf16_f32 v209, v191, v199
  v_cvt_pk_bf16_f32 v210, v193, v201
  v_cvt_pk_bf16_f32 v211, v195, v203
  v_cndmask_b32_dpp v212, v205, v204, vcc quad_perm:[0,0,2,2] row_mask:0xf bank_mask:0xf
  v_cndmask_b32_dpp v214, v207, v206, vcc quad_perm:[0,0,2,2] row_mask:0xf bank_mask:0xf
  v_cndmask_b32_dpp v216, v209, v208, vcc quad_perm:[0,0,2,2] row_mask:0xf bank_mask:0xf
  v_cndmask_b32_dpp v218, v211, v210, vcc quad_perm:[0,0,2,2] row_mask:0xf bank_mask:0xf
  s_not_b64 vcc, vcc
  v_cndmask_b32_dpp v213, v204, v205, vcc quad_perm:[1,1,3,3] row_mask:0xf bank_mask:0xf
  v_cndmask_b32_dpp v215, v206, v207, vcc quad_perm:[1,1,3,3] row_mask:0xf bank_mask:0xf
  v_cndmask_b32_dpp v217, v208, v209, vcc quad_perm:[1,1,3,3] row_mask:0xf bank_mask:0xf
  v_cndmask_b32_dpp v219, v210, v211, vcc quad_perm:[1,1,3,3] row_mask:0xf bank_mask:0xf
  s_mov_b32 vcc_lo, 0x33333333
  s_mov_b32 vcc_hi, 0x33333333
  v_cndmask_b32_dpp v204, v214, v212, vcc quad_perm:[0,1,0,1] row_mask:0xf bank_mask:0xf
  v_cndmask_b32_dpp v205, v215, v213, vcc quad_perm:[0,1,0,1] row_mask:0xf bank_mask:0xf
  v_cndmask_b32_dpp v208, v218, v216, vcc quad_perm:[0,1,0,1] row_mask:0xf bank_mask:0xf
  v_cndmask_b32_dpp v209, v219, v217, vcc quad_perm:[0,1,0,1] row_mask:0xf bank_mask:0xf
  s_not_b64 vcc, vcc
  v_cndmask_b32_dpp v206, v212, v214, vcc quad_perm:[2,3,2,3] row_mask:0xf bank_mask:0xf
  v_cndmask_b32_dpp v207, v213, v215, vcc quad_perm:[2,3,2,3] row_mask:0xf bank_mask:0xf
  v_cndmask_b32_dpp v210, v216, v218, vcc quad_perm:[2,3,2,3] row_mask:0xf bank_mask:0xf
  v_cndmask_b32_dpp v211, v217, v219, vcc quad_perm:[2,3,2,3] row_mask:0xf bank_mask:0xf
  v_permlane16_swap_b32 v204, v205
  v_permlane16_swap_b32 v208, v209
  v_permlane16_swap_b32 v206, v207
  v_permlane16_swap_b32 v210, v211
  s_nop 0
  v_permlane32_swap_b32 v204, v206
  v_permlane32_swap_b32 v205, v207
  v_permlane32_swap_b32 v208, v210
  v_permlane32_swap_b32 v209, v211
  buffer_store_dwordx4 v[204:207], v234, s[48:51], s70 offen sc1
  buffer_store_dwordx4 v[208:211], v234, s[48:51], s71 offen sc1
  s_setprio 2
  s_and_b32 s64, s55, 3
  s_lshl2_add_u32 s64, s64, s61
  s_mul_i32 s62, s64, 14
  v_lshrrev_b32 v1, 2, v255
  v_add_u32 v1, s62, v1
  v_and_b32 v2, -32, v1
  v_add_u32 v1, v1, v2
  v_and_b32 v2, 3, v255
  v_lshlrev_b32 v2, 7, v2
  v_lshl_add_u32 v1, v1, 10, v2
  s_lshr_b32 s62, s54, 1
  s_mul_i32 s62, s62, 896
  s_and_b32 s63, s2, 1
  s_add_u32 s62, s62, s63
  s_lshl_b32 s62, s62, 9
  s_add_u32 s63, s62, 32768
  s_mov_b32 exec_hi, 0xffffff
  buffer_load_dword v5, v1, s[32:35], s62 offen
  s_mov_b64 exec, -1
  s_mov_b32 exec_hi, 0xffffff
  buffer_load_dword v6, v1, s[32:35], s63 offen
  s_mov_b64 exec, -1
  s_waitcnt vmcnt(2)
  s_barrier
  s_barrier
  s_barrier
  s_mul_i32 s62, s64, 56
  v_add_u32 v1, s62, v255
  v_and_b32 v2, -32, v1
  v_add_lshl_u32 v1, v1, v2, 10
  s_lshl_b32 s62, s31, 7
  s_add_u32 s62, s62, 32768
  s_mov_b32 exec_hi, 0xffffff
  buffer_load_dword v8, v1, s[32:35], s62 offen
  s_mov_b64 exec, -1
  s_branch L_F_join

L_F2:
  s_mov_b32 s34, 1835008
  s_mov_b32 s35, 0x20000
  s_mov_b32 s50, 16777216
  s_mov_b32 s51, 0x20000
  s_bfe_u32 s79, s55, 0x10002
  s_lshl1_add_u32 s79, s58, s79
  s_lshr_b32 s31, s55, 3
  s_xor_b32 s31, s31, 3
  s_and_b32 s3, s2, 1
  s_lshl2_add_u32 s31, s3, s31
  s_lshr_b32 s3, s54, 1
  s_lshl1_add_u32 s3, s55, s3
  s_mul_i32 s73, s61, 4144
  s_add_u32 s73, s73, 131072
  v_lshl_add_u32 v6, v255, 2, s73
  ds_write_b32 v6, v254
  s_lshl_b32 s73, s61, 8
  s_add_u32 s73, s73, 147712
  v_lshl_add_u32 v6, v255, 2, s73
  ds_write_b32 v6, v254
  v_mov_b32 v7, 160000
  v_lshl_add_u32 v6, v255, 2, v7
  ds_write_b32 v6, v254
  v_lshrrev_b32 v8, 3, v255
  v_and_b32 v9, 7, v255
  v_and_b32 v7, 1, v8
  v_lshl_add_u32 v7, v7, 2, v3
  v_mul_u32_u24 v7, 16640, v7
  v_lshl_add_u32 v234, v9, 4, v7
  s_mul_i32 s70, s65, 133120
  s_lshl_b32 s71, s64, 7
  s_add_u32 s70, s70, s71
  s_add_u32 s70, s70, 262144
  s_add_u32 s71, s70, 8320
  v_bfe_u32 v12, v255, 1, 3
  v_xor_b32 v12, v12, v3
  v_lshlrev_b32 v12, 4, v12
  v_lshl_add_u32 v12, v1, 7, v12
  s_lshl_b32 s77, s62, 13
  v_add_u32 v236, s77, v12
  v_xor_b32 v237, 64, v236
  v_add_u32 v238, 0x10000, v236
  v_add_u32 v239, 0x10000, v237
  v_bfe_u32 v12, v255, 2, 2
  v_and_b32 v13, 3, v255
  v_bfe_u32 v14, v255, 2, 3
  s_lshl_b32 s77, s63, 2
  v_xor_b32 v16, s77, v14
  v_lshlrev_b32 v15, 3, v13
  v_lshl_add_u32 v16, v16, 5, v15
  v_lshl_add_u32 v16, v12, 8, v16
  v_lshl_add_u32 v16, v3, 11, v16
  v_add_u32 v240, 16384, v16
  v_xor_b32 v241, 32, v240
  v_xor_b32 v242, 64, v240
  v_xor_b32 v243, 96, v240
  v_add_u32 v244, 0x10000, v240
  v_add_u32 v245, 0x10000, v241
  v_add_u32 v246, 0x10000, v242
  v_add_u32 v247, 0x10000, v243
  v_bfe_u32 v16, v255, 3, 2
  v_lshl_add_u32 v16, v16, 5, v15
  v_lshrrev_b32 v17, 2, v255
  v_lshl_add_u32 v16, v17, 7, v16
  s_lshl_b32 s69, s61, 14
  s_lshl_b32 s78, s63, 12
  s_sub_u32 s78, 0x10000, s78
  v_add_u32 v248, s69, v16
  v_xor_b32 v249, 32, v248
  v_xor_b32 v250, 64, v248
  v_xor_b32 v251, 96, v248
  v_lshlrev_b32 v16, 1, v3
  v_xor_b32 v16, v16, v9
  v_lshlrev_b32 v16, 4, v16
  v_lshl_add_u32 v232, v8, 10, v16
  s_lshl_b32 s77, s62, 10
  s_add_u32 s77, s77, 156928
  v_lshl_add_u32 v230, v1, 4, s77
  s_lshl_b32 s77, s63, 9
  s_add_u32 s77, s77, 158976
  v_lshl_add_u32 v16, v3, 5, v15
  v_add_u32 v231, s77, v16
  v_lshlrev_b32 v235, 4, v201
  s_lshl_b32 s28, s28, 5
  s_add_u32 s28, s28, 32768
  s_lshl2_add_u32 s29, s56, s57
  s_add_u32 s29, s29, 128
  s_cmp_lt_u32 s57, 4
  s_cselect_b32 s29, s29, 262144
  s_lshl3_add_u32 s30, s57, s56
  s_add_u32 s30, s30, 64
  s_cmp_lt_u32 s56, 8
  s_cselect_b32 s30, s30, 262144
  s_cmp_eq_u32 s61, 1
  s_cselect_b32 s29, s29, 262144
  s_cmp_eq_u32 s61, 2
  s_cselect_b32 s29, s30, s29
  s_lshl_b32 s29, s29, 7
  s_mov_b32 s64, 0x05040100
  s_mov_b32 s65, 0x07060302
  s_waitcnt lgkmcnt(0)
  s_mov_b64 exec, 0
  s_cmp_eq_u32 s61, 0
  s_cbranch_scc1 L_warm_a0
  s_cmp_eq_u32 s61, 1
  s_cbranch_scc1 L_warm_b0
  s_cmp_eq_u32 s61, 2
  s_cbranch_scc1 L_warm_c0
  s_branch L_warm_d0
L_warm_ret:
  s_mov_b64 exec, -1
  s_cmp_eq_u32 s57, 3
  s_cbranch_scc1 L_F_aux
  v_mov_b32 v202, 0x3f803f80
  s_waitcnt vmcnt(21)
  v_dot2_f32_bf16 v204, v120, v202, 0
  v_dot2_f32_bf16 v205, v120, v120, 0
  v_dot2_f32_bf16 v204, v121, v202, v204
  v_dot2_f32_bf16 v205, v121, v121, v205
  v_dot2_f32_bf16 v204, v122, v202, v204
  v_dot2_f32_bf16 v205, v122, v122, v205
  v_dot2_f32_bf16 v204, v123, v202, v204
  v_dot2_f32_bf16 v205, v123, v123, v205
  s_waitcnt vmcnt(20)
  v_dot2_f32_bf16 v204, v124, v202, v204
  v_dot2_f32_bf16 v205, v124, v124, v205
  v_dot2_f32_bf16 v204, v125, v202, v204
  v_dot2_f32_bf16 v205, v125, v125, v205
  v_dot2_f32_bf16 v204, v126, v202, v204
  v_dot2_f32_bf16 v205, v126, v126, v205
  v_dot2_f32_bf16 v204, v127, v202, v204
  v_dot2_f32_bf16 v205, v127, v127, v205
  s_nop 1
  v_add_f32_dpp v204, v204, v204 row_ror:8 row_mask:0xf bank_mask:0xf
  v_add_f32_dpp v205, v205, v205 row_ror:8 row_mask:0xf bank_mask:0xf
  s_nop 0
  v_add_f32_dpp v204, v204, v204 row_ror:4 row_mask:0xf bank_mask:0xf
  v_add_f32_dpp v205, v205, v205 row_ror:4 row_mask:0xf bank_mask:0xf
  s_nop 0
  v_add_f32_dpp v204, v204, v204 row_ror:2 row_mask:0xf bank_mask:0xf
  v_add_f32_dpp v205, v205, v205 row_ror:2 row_mask:0xf bank_mask:0xf
  s_nop 0
  v_add_f32_dpp v204, v204, v204 row_ror:1 row_mask:0xf bank_mask:0xf
  v_add_f32_dpp v205, v205, v205 row_ror:1 row_mask:0xf bank_mask:0xf
  v_mov_b32 v206, v204
  v_mov_b32 v207, v205
  s_nop 0
  v_permlane16_swap_b32 v204, v206
  v_permlane16_swap_b32 v205, v207
  v_add_f32 v204, v204, v206
  v_add_f32 v205, v205, v207
  v_mul_f32 v204, 0x3b000000, v204
  v_mul_f32 v205, 0x3b000000, v205
  v_fma_f32 v205, -v204, v204, v205
  v_max_f32 v205, 0, v205
  v_cvt_pk_bf16_f32 v204, v204, v205
  v_and_b32 v205, 0xffff0000, v204
  v_lshlrev_b32 v204, 16, v204
  v_add_f32 v205, 0x3727c5ac, v205
  v_cvt_pk_bf16_f32 v205, v205, v205
  v_lshlrev_b32 v205, 16, v205
  v_sqrt_f32 v205, v205
  s_nop 0
  v_cvt_pk_bf16_f32 v205, v205, v205
  v_lshlrev_b32 v205, 16, v205
  v_rcp_f32 v206, v205
  v_cvt_pk_bf16_f32 v220, -v204, -v204
  v_cvt_pk_bf16_f32 v221, -v204, v205
  v_mul_f32 v222, 0xc0135761, v206
  v_mul_f32 v207, v206, v206
  v_mul_f32 v207, 0x3d372713, v207
  v_mul_f32 v223, v222, v207
  s_mov_b32 exec_lo, 1
  s_mov_b32 exec_hi, 1
  buffer_store_dwordx4 v[220:223], v235, s[48:51], s28 offen sc1
  s_mov_b64 exec, 3
  buffer_store_dword v254, v252, s[48:51], s29 offen sc1
  s_mov_b64 exec, -1
  s_waitcnt vmcnt(20)
  v_perm_b32 v152, v128, v129, s64
  v_perm_b32 v153, v128, v129, s65
  s_waitcnt vmcnt(19)
  v_perm_b32 v154, v129, v130, s64
  v_perm_b32 v155, v129, v130, s65
  s_waitcnt vmcnt(17)
  v_perm_b32 v156, v130, v131, s64
  v_perm_b32 v157, v130, v131, s65
  s_waitcnt vmcnt(16)
  v_perm_b32 v158, v131, v132, s64
  v_perm_b32 v159, v131, v132, s65
  s_waitcnt vmcnt(15)
  v_perm_b32 v160, v132, v133, s64
  v_perm_b32 v161, v132, v133, s65
  s_waitcnt vmcnt(14)
  v_perm_b32 v162, v133, v134, s64
  v_perm_b32 v163, v133, v134, s65
  s_waitcnt vmcnt(13)
  v_perm_b32 v164, v134, v135, s64
  v_perm_b32 v165, v134, v135, s65
  s_waitcnt vmcnt(12)
  v_perm_b32 v166, v135, v136, s64
  v_perm_b32 v167, v135, v136, s65
  s_waitcnt vmcnt(11)
  v_perm_b32 v168, v136, v137, s64
  v_perm_b32 v169, v136, v137, s65
  s_waitcnt vmcnt(10)
  v_perm_b32 v170, v137, v138, s64
  v_perm_b32 v171, v137, v138, s65
  v_dot2_f32_bf16 v172, v152, v149, 0
  v_dot2_f32_bf16 v173, v153, v151, 0
  v_dot2_f32_bf16 v174, v154, v149, 0
  v_dot2_f32_bf16 v175, v155, v151, 0
  v_dot2_f32_bf16 v176, v156, v149, 0
  v_dot2_f32_bf16 v177, v157, v151, 0
  v_dot2_f32_bf16 v178, v158, v149, 0
  v_dot2_f32_bf16 v179, v159, v151, 0
  v_dot2_f32_bf16 v180, v160, v149, 0
  v_dot2_f32_bf16 v181, v161, v151, 0
  v_dot2_f32_bf16 v182, v162, v149, 0
  v_dot2_f32_bf16 v183, v163, v151, 0
  v_dot2_f32_bf16 v184, v164, v149, 0
  v_dot2_f32_bf16 v185, v165, v151, 0
  v_dot2_f32_bf16 v186, v166, v149, 0
  v_dot2_f32_bf16 v187, v167, v151, 0
  v_dot2_f32_bf16 v172, v156, v148, v172
  v_dot2_f32_bf16 v173, v157, v150, v173
  v_dot2_f32_bf16 v174, v158, v148, v174
  v_dot2_f32_bf16 v175, v159, v150, v175
  v_dot2_f32_bf16 v176, v160, v148, v176
  v_dot2_f32_bf16 v177, v161, v150, v177
  v_dot2_f32_bf16 v178, v162, v148, v178
  v_dot2_f32_bf16 v179, v163, v150, v179
  v_dot2_f32_bf16 v180, v164, v148, v180
  v_dot2_f32_bf16 v181, v165, v150, v181
  v_dot2_f32_bf16 v182, v166, v148, v182
  v_dot2_f32_bf16 v183, v167, v150, v183
  v_dot2_f32_bf16 v184, v168, v148, v184
  v_dot2_f32_bf16 v185, v169, v150, v185
  v_dot2_f32_bf16 v186, v170, v148, v186
  v_dot2_f32_bf16 v187, v171, v150, v187
  s_waitcnt vmcnt(9)
  v_lshlrev_b32 v188, 16, v140
  v_and_b32 v189, 0xffff0000, v140
  s_waitcnt vmcnt(8)
  v_lshlrev_b32 v190, 16, v141
  v_and_b32 v191, 0xffff0000, v141
  s_waitcnt vmcnt(7)
  v_lshlrev_b32 v192, 16, v142
  v_and_b32 v193, 0xffff0000, v142
  s_waitcnt vmcnt(6)
  v_lshlrev_b32 v194, 16, v143
  v_and_b32 v195, 0xffff0000, v143
  s_waitcnt vmcnt(5)
  v_lshlrev_b32 v196, 16, v144
  v_and_b32 v197, 0xffff0000, v144
  s_waitcnt vmcnt(4)
  v_lshlrev_b32 v198, 16, v145
  v_and_b32 v199, 0xffff0000, v145
  s_waitcnt vmcnt(3)
  v_lshlrev_b32 v200, 16, v146
  v_and_b32 v201, 0xffff0000, v146
  s_waitcnt vmcnt(2)
  v_lshlrev_b32 v202, 16, v147
  v_and_b32 v203, 0xffff0000, v147
  v_pk_mul_f32 v[188:189], v[188:189], v[172:173]
  v_pk_mul_f32 v[190:191], v[190:191], v[174:175]
  v_pk_mul_f32 v[192:193], v[192:193], v[176:177]
  v_pk_mul_f32 v[194:195], v[194:195], v[178:179]
  v_pk_mul_f32 v[196:197], v[196:197], v[180:181]
  v_pk_mul_f32 v[198:199], v[198:199], v[182:183]
  v_pk_mul_f32 v[200:201], v[200:201], v[184:185]
  v_pk_mul_f32 v[202:203], v[202:203], v[186:187]
  s_mov_b32 vcc_lo, 0x55555555
  s_mov_b32 vcc_hi, 0x55555555
  v_cvt_pk_bf16_f32 v204, v188, v196
  v_cvt_pk_bf16_f32 v205, v190, v198
  v_cvt_pk_bf16_f32 v206, v192, v200
  v_cvt_pk_bf16_f32 v207, v194, v202
  v_cvt_pk_bf16_f32 v208, v189, v197
  v_cvt_pk_bf16_f32 v209, v191, v199
  v_cvt_pk_bf16_f32 v210, v193, v201
  v_cvt_pk_bf16_f32 v211, v195, v203
  v_cndmask_b32_dpp v212, v205, v204, vcc quad_perm:[0,0,2,2] row_mask:0xf bank_mask:0xf
  v_cndmask_b32_dpp v214, v207, v206, vcc quad_perm:[0,0,2,2] row_mask:0xf bank_mask:0xf
  v_cndmask_b32_dpp v216, v209, v208, vcc quad_perm:[0,0,2,2] row_mask:0xf bank_mask:0xf
  v_cndmask_b32_dpp v218, v211, v210, vcc quad_perm:[0,0,2,2] row_mask:0xf bank_mask:0xf
  s_not_b64 vcc, vcc
  v_cndmask_b32_dpp v213, v204, v205, vcc quad_perm:[1,1,3,3] row_mask:0xf bank_mask:0xf
  v_cndmask_b32_dpp v215, v206, v207, vcc quad_perm:[1,1,3,3] row_mask:0xf bank_mask:0xf
  v_cndmask_b32_dpp v217, v208, v209, vcc quad_perm:[1,1,3,3] row_mask:0xf bank_mask:0xf
  v_cndmask_b32_dpp v219, v210, v211, vcc quad_perm:[1,1,3,3] row_mask:0xf bank_mask:0xf
  s_mov_b32 vcc_lo, 0x33333333
  s_mov_b32 vcc_hi, 0x33333333
  v_cndmask_b32_dpp v204, v214, v212, vcc quad_perm:[0,1,0,1] row_mask:0xf bank_mask:0xf
  v_cndmask_b32_dpp v205, v215, v213, vcc quad_perm:[0,1,0,1] row_mask:0xf bank_mask:0xf
  v_cndmask_b32_dpp v208, v218, v216, vcc quad_perm:[0,1,0,1] row_mask:0xf bank_mask:0xf
  v_cndmask_b32_dpp v209, v219, v217, vcc quad_perm:[0,1,0,1] row_mask:0xf bank_mask:0xf
  s_not_b64 vcc, vcc
  v_cndmask_b32_dpp v206, v212, v214, vcc quad_perm:[2,3,2,3] row_mask:0xf bank_mask:0xf
  v_cndmask_b32_dpp v207, v213, v215, vcc quad_perm:[2,3,2,3] row_mask:0xf bank_mask:0xf
  v_cndmask_b32_dpp v210, v216, v218, vcc quad_perm:[2,3,2,3] row_mask:0xf bank_mask:0xf
  v_cndmask_b32_dpp v211, v217, v219, vcc quad_perm:[2,3,2,3] row_mask:0xf bank_mask:0xf
  v_permlane16_swap_b32 v204, v205
  v_permlane16_swap_b32 v208, v209
  v_permlane16_swap_b32 v206, v207
  v_permlane16_swap_b32 v210, v211
  s_nop 0
  v_permlane32_swap_b32 v204, v206
  v_permlane32_swap_b32 v205, v207
  v_permlane32_swap_b32 v208, v210
  v_permlane32_swap_b32 v209, v211
  buffer_store_dwordx4 v[204:207], v234, s[48:51], s70 offen sc1
  buffer_store_dwordx4 v[208:211], v234, s[48:51], s71 offen sc1
  s_lshl1_add_u32 s64, s58, s62
  s_lshl1_add_u32 s65, s59, s63
  s_mul_i32 s73, s64, 229376
  s_lshl_b32 s75, s65, 13
  s_add_u32 s73, s73, s75
  s_add_u32 s73, s73, 5242880
  s_mul_i32 s75, s65, 37
  s_lshr_b32 s75, s75, 8
  s_lshl2_add_u32 s74, s64, s75
  s_add_u32 s74, s74, 128
  s_lshl_b32 s74, s74, 7
  s_add_u32 s62, s61, s3
  s_and_b32 s62, s62, 3
  s_mul_i32 s75, s62, 3584
  s_add_u32 s75, s75, s31
  s_add_u32 s75, s75, 256
  s_lshl_b32 s75, s75, 7
  s_lshl2_add_u32 s62, s79, s62
  s_mul_i32 s76, s62, 57344
  s_add_u32 s76, s76, 5242880
  s_add_u32 s77, s76, 4096
  s_add_u32 s62, s62, 128
  s_lshl_b32 s68, s62, 7
  s_add_u32 s66, s68, 16
  s_barrier
  ds_read_b64_tr_b16 v[64:65], v240 offset:0
  ds_read_b64_tr_b16 v[66:67], v240 offset:1024
  ds_read_b128 v[80:83], v236 offset:0
  ds_read_b128 v[84:87], v236 offset:2048
  ds_read_b128 v[88:91], v236 offset:4096
  ds_read_b128 v[92:95], v236 offset:6144
  ds_read_b64_tr_b16 v[68:69], v241 offset:0
  ds_read_b64_tr_b16 v[70:71], v241 offset:1024
  ds_read_b64_tr_b16 v[72:73], v242 offset:0
  ds_read_b64_tr_b16 v[74:75], v242 offset:1024
  ds_read_b64_tr_b16 v[76:77], v243 offset:0
  ds_read_b64_tr_b16 v[78:79], v243 offset:1024
  s_waitcnt lgkmcnt(9)
  v_mfma_f32_16x16x32_bf16 v[0:3], v[64:67], v[80:83], 0
  s_waitcnt lgkmcnt(8)
  v_mfma_f32_16x16x32_bf16 v[8:11], v[64:67], v[84:87], 0
  s_waitcnt lgkmcnt(0)
  v_mfma_f32_16x16x32_bf16 v[16:19], v[64:67], v[88:91], 0
  ds_read_b64_tr_b16 v[96:97], v240 offset:8192
  v_mfma_f32_16x16x32_bf16 v[24:27], v[64:67], v[92:95], 0
  ds_read_b64_tr_b16 v[98:99], v240 offset:9216
  v_mfma_f32_16x16x32_bf16 v[4:7], v[68:71], v[80:83], 0
  ds_read_b128 v[112:115], v237 offset:0
  v_mfma_f32_16x16x32_bf16 v[12:15], v[68:71], v[84:87], 0
  ds_read_b128 v[116:119], v237 offset:2048
  v_mfma_f32_16x16x32_bf16 v[20:23], v[68:71], v[88:91], 0
  ds_read_b128 v[120:123], v237 offset:4096
  v_mfma_f32_16x16x32_bf16 v[28:31], v[68:71], v[92:95], 0
  ds_read_b128 v[124:127], v237 offset:6144
  v_mfma_f32_16x16x32_bf16 v[32:35], v[72:75], v[80:83], 0
  ds_read_b64_tr_b16 v[100:101], v241 offset:8192
  v_mfma_f32_16x16x32_bf16 v[40:43], v[72:75], v[84:87], 0
  ds_read_b64_tr_b16 v[102:103], v241 offset:9216
  v_mfma_f32_16x16x32_bf16 v[48:51], v[72:75], v[88:91], 0
  ds_read_b64_tr_b16 v[104:105], v242 offset:8192
  v_mfma_f32_16x16x32_bf16 v[56:59], v[72:75], v[92:95], 0
  ds_read_b64_tr_b16 v[106:107], v242 offset:9216
  v_mfma_f32_16x16x32_bf16 v[36:39], v[76:79], v[80:83], 0
  ds_read_b64_tr_b16 v[108:109], v243 offset:8192
  v_mfma_f32_16x16x32_bf16 v[44:47], v[76:79], v[84:87], 0
  ds_read_b64_tr_b16 v[110:111], v243 offset:9216
  v_mfma_f32_16x16x32_bf16 v[52:55], v[76:79], v[88:91], 0
  v_mfma_f32_16x16x32_bf16 v[60:63], v[76:79], v[92:95], 0
  s_waitcnt lgkmcnt(6)
  v_mfma_f32_16x16x32_bf16 v[0:3], v[96:99], v[112:115], v[0:3]
  v_mfma_f32_16x16x32_bf16 v[8:11], v[96:99], v[116:119], v[8:11]
  s_waitcnt lgkmcnt(0)
  s_waitcnt vmcnt(2)
  s_waitcnt vmcnt(0)
  s_barrier
  v_mfma_f32_16x16x32_bf16 v[16:19], v[96:99], v[120:123], v[16:19]
  ds_read_b64_tr_b16 v[64:65], v240 offset:32768
  v_mfma_f32_16x16x32_bf16 v[24:27], v[96:99], v[124:127], v[24:27]
  ds_read_b64_tr_b16 v[66:67], v240 offset:33792
  v_mfma_f32_16x16x32_bf16 v[4:7], v[100:103], v[112:115], v[4:7]
  ds_read_b128 v[80:83], v236 offset:32768
  v_mfma_f32_16x16x32_bf16 v[12:15], v[100:103], v[116:119], v[12:15]
  ds_read_b128 v[84:87], v236 offset:34816
  v_mfma_f32_16x16x32_bf16 v[20:23], v[100:103], v[120:123], v[20:23]
  ds_read_b128 v[88:91], v236 offset:36864
  v_mfma_f32_16x16x32_bf16 v[28:31], v[100:103], v[124:127], v[28:31]
  ds_read_b128 v[92:95], v236 offset:38912
  v_mfma_f32_16x16x32_bf16 v[32:35], v[104:107], v[112:115], v[32:35]
  ds_read_b64_tr_b16 v[68:69], v241 offset:32768
  v_mfma_f32_16x16x32_bf16 v[40:43], v[104:107], v[116:119], v[40:43]
  ds_read_b64_tr_b16 v[70:71], v241 offset:33792
  v_mfma_f32_16x16x32_bf16 v[48:51], v[104:107], v[120:123], v[48:51]
  ds_read_b64_tr_b16 v[72:73], v242 offset:32768
  v_mfma_f32_16x16x32_bf16 v[56:59], v[104:107], v[124:127], v[56:59]
  ds_read_b64_tr_b16 v[74:75], v242 offset:33792
  v_mfma_f32_16x16x32_bf16 v[36:39], v[108:111], v[112:115], v[36:39]
  ds_read_b64_tr_b16 v[76:77], v243 offset:32768
  v_mfma_f32_16x16x32_bf16 v[44:47], v[108:111], v[116:119], v[44:47]
  ds_read_b64_tr_b16 v[78:79], v243 offset:33792
  v_mfma_f32_16x16x32_bf16 v[52:55], v[108:111], v[120:123], v[52:55]
  v_mfma_f32_16x16x32_bf16 v[60:63], v[108:111], v[124:127], v[60:63]
  s_waitcnt lgkmcnt(6)
  v_mfma_f32_16x16x32_bf16 v[0:3], v[64:67], v[80:83], v[0:3]
  v_mfma_f32_16x16x32_bf16 v[8:11], v[64:67], v[84:87], v[8:11]
  s_waitcnt lgkmcnt(0)
  v_mfma_f32_16x16x32_bf16 v[16:19], v[64:67], v[88:91], v[16:19]
  ds_read_b64_tr_b16 v[96:97], v240 offset:40960
  v_mfma_f32_16x16x32_bf16 v[24:27], v[64:67], v[92:95], v[24:27]
  ds_read_b64_tr_b16 v[98:99], v240 offset:41984
  v_mfma_f32_16x16x32_bf16 v[4:7], v[68:71], v[80:83], v[4:7]
  ds_read_b128 v[112:115], v237 offset:32768
  v_mfma_f32_16x16x32_bf16 v[12:15], v[68:71], v[84:87], v[12:15]
  ds_read_b128 v[116:119], v237 offset:34816
  v_mfma_f32_16x16x32_bf16 v[20:23], v[68:71], v[88:91], v[20:23]
  ds_read_b128 v[120:123], v237 offset:36864
  v_mfma_f32_16x16x32_bf16 v[28:31], v[68:71], v[92:95], v[28:31]
  ds_read_b128 v[124:127], v237 offset:38912
  v_mfma_f32_16x16x32_bf16 v[32:35], v[72:75], v[80:83], v[32:35]
  ds_read_b64_tr_b16 v[100:101], v241 offset:40960
  v_mfma_f32_16x16x32_bf16 v[40:43], v[72:75], v[84:87], v[40:43]
  ds_read_b64_tr_b16 v[102:103], v241 offset:41984
  v_mfma_f32_16x16x32_bf16 v[48:51], v[72:75], v[88:91], v[48:51]
  ds_read_b64_tr_b16 v[104:105], v242 offset:40960
  v_mfma_f32_16x16x32_bf16 v[56:59], v[72:75], v[92:95], v[56:59]
  ds_read_b64_tr_b16 v[106:107], v242 offset:41984
  v_mfma_f32_16x16x32_bf16 v[36:39], v[76:79], v[80:83], v[36:39]
  ds_read_b64_tr_b16 v[108:109], v243 offset:40960
  v_mfma_f32_16x16x32_bf16 v[44:47], v[76:79], v[84:87], v[44:47]
  ds_read_b64_tr_b16 v[110:111], v243 offset:41984
  v_mfma_f32_16x16x32_bf16 v[52:55], v[76:79], v[88:91], v[52:55]
  v_mfma_f32_16x16x32_bf16 v[60:63], v[76:79], v[92:95], v[60:63]
  s_waitcnt lgkmcnt(6)
  v_mfma_f32_16x16x32_bf16 v[0:3], v[96:99], v[112:115], v[0:3]
  v_mfma_f32_16x16x32_bf16 v[8:11], v[96:99], v[116:119], v[8:11]
  s_waitcnt lgkmcnt(0)
  s_barrier
  v_mfma_f32_16x16x32_bf16 v[16:19], v[96:99], v[120:123], v[16:19]
  ds_read_b64_tr_b16 v[64:65], v244 offset:0
  v_mfma_f32_16x16x32_bf16 v[24:27], v[96:99], v[124:127], v[24:27]
  ds_read_b64_tr_b16 v[66:67], v244 offset:1024
  v_mfma_f32_16x16x32_bf16 v[4:7], v[100:103], v[112:115], v[4:7]
  ds_read_b128 v[80:83], v238 offset:0
  v_mfma_f32_16x16x32_bf16 v[12:15], v[100:103], v[116:119], v[12:15]
  ds_read_b128 v[84:87], v238 offset:2048
  v_mfma_f32_16x16x32_bf16 v[20:23], v[100:103], v[120:123], v[20:23]
  ds_read_b128 v[88:91], v238 offset:4096
  v_mfma_f32_16x16x32_bf16 v[28:31], v[100:103], v[124:127], v[28:31]
  ds_read_b128 v[92:95], v238 offset:6144
  v_mfma_f32_16x16x32_bf16 v[32:35], v[104:107], v[112:115], v[32:35]
  ds_read_b64_tr_b16 v[68:69], v245 offset:0
  v_mfma_f32_16x16x32_bf16 v[40:43], v[104:107], v[116:119], v[40:43]
  ds_read_b64_tr_b16 v[70:71], v245 offset:1024
  v_mfma_f32_16x16x32_bf16 v[48:51], v[104:107], v[120:123], v[48:51]
  ds_read_b64_tr_b16 v[72:73], v246 offset:0
  v_mfma_f32_16x16x32_bf16 v[56:59], v[104:107], v[124:127], v[56:59]
  ds_read_b64_tr_b16 v[74:75], v246 offset:1024
  v_mfma_f32_16x16x32_bf16 v[36:39], v[108:111], v[112:115], v[36:39]
  ds_read_b64_tr_b16 v[76:77], v247 offset:0
  v_mfma_f32_16x16x32_bf16 v[44:47], v[108:111], v[116:119], v[44:47]
  ds_read_b64_tr_b16 v[78:79], v247 offset:1024
  v_mfma_f32_16x16x32_bf16 v[52:55], v[108:111], v[120:123], v[52:55]
  v_mfma_f32_16x16x32_bf16 v[60:63], v[108:111], v[124:127], v[60:63]
  s_waitcnt lgkmcnt(6)
  v_mfma_f32_16x16x32_bf16 v[0:3], v[64:67], v[80:83], v[0:3]
  v_mfma_f32_16x16x32_bf16 v[8:11], v[64:67], v[84:87], v[8:11]
  s_waitcnt lgkmcnt(0)
  v_mfma_f32_16x16x32_bf16 v[16:19], v[64:67], v[88:91], v[16:19]
  ds_read_b64_tr_b16 v[96:97], v244 offset:8192
  v_mfma_f32_16x16x32_bf16 v[24:27], v[64:67], v[92:95], v[24:27]
  ds_read_b64_tr_b16 v[98:99], v244 offset:9216
  v_mfma_f32_16x16x32_bf16 v[4:7], v[68:71], v[80:83], v[4:7]
  ds_read_b128 v[112:115], v239 offset:0
  v_mfma_f32_16x16x32_bf16 v[12:15], v[68:71], v[84:87], v[12:15]
  ds_read_b128 v[116:119], v239 offset:2048
  v_mfma_f32_16x16x32_bf16 v[20:23], v[68:71], v[88:91], v[20:23]
  ds_read_b128 v[120:123], v239 offset:4096
  v_mfma_f32_16x16x32_bf16 v[28:31], v[68:71], v[92:95], v[28:31]
  ds_read_b128 v[124:127], v239 offset:6144
  v_mfma_f32_16x16x32_bf16 v[32:35], v[72:75], v[80:83], v[32:35]
  ds_read_b64_tr_b16 v[100:101], v245 offset:8192
  v_mfma_f32_16x16x32_bf16 v[40:43], v[72:75], v[84:87], v[40:43]
  ds_read_b64_tr_b16 v[102:103], v245 offset:9216
  v_mfma_f32_16x16x32_bf16 v[48:51], v[72:75], v[88:91], v[48:51]
  ds_read_b64_tr_b16 v[104:105], v246 offset:8192
  v_mfma_f32_16x16x32_bf16 v[56:59], v[72:75], v[92:95], v[56:59]
  ds_read_b64_tr_b16 v[106:107], v246 offset:9216
  v_mfma_f32_16x16x32_bf16 v[36:39], v[76:79], v[80:83], v[36:39]
  ds_read_b64_tr_b16 v[108:109], v247 offset:8192
  v_mfma_f32_16x16x32_bf16 v[44:47], v[76:79], v[84:87], v[44:47]
  ds_read_b64_tr_b16 v[110:111], v247 offset:9216
  v_mfma_f32_16x16x32_bf16 v[52:55], v[76:79], v[88:91], v[52:55]
  v_mfma_f32_16x16x32_bf16 v[60:63], v[76:79], v[92:95], v[60:63]
  s_waitcnt lgkmcnt(6)
  v_mfma_f32_16x16x32_bf16 v[0:3], v[96:99], v[112:115], v[0:3]
  v_mfma_f32_16x16x32_bf16 v[8:11], v[96:99], v[116:119], v[8:11]
  s_waitcnt lgkmcnt(0)
  s_barrier
  v_mfma_f32_16x16x32_bf16 v[16:19], v[96:99], v[120:123], v[16:19]
  ds_read_b64_tr_b16 v[64:65], v244 offset:32768
  v_mfma_f32_16x16x32_bf16 v[24:27], v[96:99], v[124:127], v[24:27]
  ds_read_b64_tr_b16 v[66:67], v244 offset:33792
  v_mfma_f32_16x16x32_bf16 v[4:7], v[100:103], v[112:115], v[4:7]
  ds_read_b128 v[80:83], v238 offset:32768
  v_mfma_f32_16x16x32_bf16 v[12:15], v[100:103], v[116:119], v[12:15]
  ds_read_b128 v[84:87], v238 offset:34816
  v_mfma_f32_16x16x32_bf16 v[20:23], v[100:103], v[120:123], v[20:23]
  ds_read_b128 v[88:91], v238 offset:36864
  v_mfma_f32_16x16x32_bf16 v[28:31], v[100:103], v[124:127], v[28:31]
  ds_read_b128 v[92:95], v238 offset:38912
  v_mfma_f32_16x16x32_bf16 v[32:35], v[104:107], v[112:115], v[32:35]
  ds_read_b64_tr_b16 v[68:69], v245 offset:32768
  v_mfma_f32_16x16x32_bf16 v[40:43], v[104:107], v[116:119], v[40:43]
  ds_read_b64_tr_b16 v[70:71], v245 offset:33792
  v_mfma_f32_16x16x32_bf16 v[48:51], v[104:107], v[120:123], v[48:51]
  ds_read_b64_tr_b16 v[72:73], v246 offset:32768
  v_mfma_f32_16x16x32_bf16 v[56:59], v[104:107], v[124:127], v[56:59]
  ds_read_b64_tr_b16 v[74:75], v246 offset:33792
  v_mfma_f32_16x16x32_bf16 v[36:39], v[108:111], v[112:115], v[36:39]
  ds_read_b64_tr_b16 v[76:77], v247 offset:32768
  v_mfma_f32_16x16x32_bf16 v[44:47], v[108:111], v[116:119], v[44:47]
  ds_read_b64_tr_b16 v[78:79], v247 offset:33792
  v_mfma_f32_16x16x32_bf16 v[52:55], v[108:111], v[120:123], v[52:55]
  v_mfma_f32_16x16x32_bf16 v[60:63], v[108:111], v[124:127], v[60:63]
  s_waitcnt lgkmcnt(6)
  v_mfma_f32_16x16x32_bf16 v[0:3], v[64:67], v[80:83], v[0:3]
  v_mfma_f32_16x16x32_bf16 v[8:11], v[64:67], v[84:87], v[8:11]
  s_waitcnt lgkmcnt(0)
  v_mfma_f32_16x16x32_bf16 v[16:19], v[64:67], v[88:91], v[16:19]
  ds_read_b64_tr_b16 v[96:97], v244 offset:40960
  v_mfma_f32_16x16x32_bf16 v[24:27], v[64:67], v[92:95], v[24:27]
  ds_read_b64_tr_b16 v[98:99], v244 offset:41984
  v_mfma_f32_16x16x32_bf16 v[4:7], v[68:71], v[80:83], v[4:7]
  ds_read_b128 v[112:115], v239 offset:32768
  v_mfma_f32_16x16x32_bf16 v[12:15], v[68:71], v[84:87], v[12:15]
  ds_read_b128 v[116:119], v239 offset:34816
  v_mfma_f32_16x16x32_bf16 v[20:23], v[68:71], v[88:91], v[20:23]
  ds_read_b128 v[120:123], v239 offset:36864
  v_mfma_f32_16x16x32_bf16 v[28:31], v[68:71], v[92:95], v[28:31]
  ds_read_b128 v[124:127], v239 offset:38912
  v_mfma_f32_16x16x32_bf16 v[32:35], v[72:75], v[80:83], v[32:35]
  ds_read_b64_tr_b16 v[100:101], v245 offset:40960
  v_mfma_f32_16x16x32_bf16 v[40:43], v[72:75], v[84:87], v[40:43]
  ds_read_b64_tr_b16 v[102:103], v245 offset:41984
  v_mfma_f32_16x16x32_bf16 v[48:51], v[72:75], v[88:91], v[48:51]
  ds_read_b64_tr_b16 v[104:105], v246 offset:40960
  v_mfma_f32_16x16x32_bf16 v[56:59], v[72:75], v[92:95], v[56:59]
  ds_read_b64_tr_b16 v[106:107], v246 offset:41984
  v_mfma_f32_16x16x32_bf16 v[36:39], v[76:79], v[80:83], v[36:39]
  ds_read_b64_tr_b16 v[108:109], v247 offset:40960
  v_mfma_f32_16x16x32_bf16 v[44:47], v[76:79], v[84:87], v[44:47]
  ds_read_b64_tr_b16 v[110:111], v247 offset:41984
  v_mfma_f32_16x16x32_bf16 v[52:55], v[76:79], v[88:91], v[52:55]
  v_mfma_f32_16x16x32_bf16 v[60:63], v[76:79], v[92:95], v[60:63]
  s_waitcnt lgkmcnt(6)
  v_mfma_f32_16x16x32_bf16 v[0:3], v[96:99], v[112:115], v[0:3]
  v_mfma_f32_16x16x32_bf16 v[8:11], v[96:99], v[116:119], v[8:11]
  s_waitcnt lgkmcnt(0)
  s_barrier
  v_mfma_f32_16x16x32_bf16 v[16:19], v[96:99], v[120:123], v[16:19]
  ds_read_b64_tr_b16 v[64:65], v240 offset:0
  v_mfma_f32_16x16x32_bf16 v[24:27], v[96:99], v[124:127], v[24:27]
  ds_read_b64_tr_b16 v[66:67], v240 offset:1024
  v_mfma_f32_16x16x32_bf16 v[4:7], v[100:103], v[112:115], v[4:7]
  ds_read_b128 v[80:83], v236 offset:0
  v_mfma_f32_16x16x32_bf16 v[12:15], v[100:103], v[116:119], v[12:15]
  ds_read_b128 v[84:87], v236 offset:2048
  v_mfma_f32_16x16x32_bf16 v[20:23], v[100:103], v[120:123], v[20:23]
  ds_read_b128 v[88:91], v236 offset:4096
  v_mfma_f32_16x16x32_bf16 v[28:31], v[100:103], v[124:127], v[28:31]
  ds_read_b128 v[92:95], v236 offset:6144
  v_mfma_f32_16x16x32_bf16 v[32:35], v[104:107], v[112:115], v[32:35]
  ds_read_b64_tr_b16 v[68:69], v241 offset:0
  v_mfma_f32_16x16x32_bf16 v[40:43], v[104:107], v[116:119], v[40:43]
  ds_read_b64_tr_b16 v[70:71], v241 offset:1024
  v_mfma_f32_16x16x32_bf16 v[48:51], v[104:107], v[120:123], v[48:51]
  ds_read_b64_tr_b16 v[72:73], v242 offset:0
  v_mfma_f32_16x16x32_bf16 v[56:59], v[104:107], v[124:127], v[56:59]
  ds_read_b64_tr_b16 v[74:75], v242 offset:1024
  v_mfma_f32_16x16x32_bf16 v[36:39], v[108:111], v[112:115], v[36:39]
  ds_read_b64_tr_b16 v[76:77], v243 offset:0
  v_mfma_f32_16x16x32_bf16 v[44:47], v[108:111], v[116:119], v[44:47]
  ds_read_b64_tr_b16 v[78:79], v243 offset:1024
  v_mfma_f32_16x16x32_bf16 v[52:55], v[108:111], v[120:123], v[52:55]
  v_mfma_f32_16x16x32_bf16 v[60:63], v[108:111], v[124:127], v[60:63]
  s_waitcnt lgkmcnt(6)
  v_mfma_f32_16x16x32_bf16 v[0:3], v[64:67], v[80:83], v[0:3]
  v_mfma_f32_16x16x32_bf16 v[8:11], v[64:67], v[84:87], v[8:11]
  s_waitcnt lgkmcnt(0)
  v_mfma_f32_16x16x32_bf16 v[16:19], v[64:67], v[88:91], v[16:19]
  ds_read_b64_tr_b16 v[96:97], v240 offset:8192
  v_mfma_f32_16x16x32_bf16 v[24:27], v[64:67], v[92:95], v[24:27]
  ds_read_b64_tr_b16 v[98:99], v240 offset:9216
  v_mfma_f32_16x16x32_bf16 v[4:7], v[68:71], v[80:83], v[4:7]
  ds_read_b128 v[112:115], v237 offset:0
  v_mfma_f32_16x16x32_bf16 v[12:15], v[68:71], v[84:87], v[12:15]
  ds_read_b128 v[116:119], v237 offset:2048
  v_mfma_f32_16x16x32_bf16 v[20:23], v[68:71], v[88:91], v[20:23]
  ds_read_b128 v[120:123], v237 offset:4096
  v_mfma_f32_16x16x32_bf16 v[28:31], v[68:71], v[92:95], v[28:31]
  ds_read_b128 v[124:127], v237 offset:6144
  v_mfma_f32_16x16x32_bf16 v[32:35], v[72:75], v[80:83], v[32:35]
  ds_read_b64_tr_b16 v[100:101], v241 offset:8192
  v_mfma_f32_16x16x32_bf16 v[40:43], v[72:75], v[84:87], v[40:43]
  ds_read_b64_tr_b16 v[102:103], v241 offset:9216
  v_mfma_f32_16x16x32_bf16 v[48:51], v[72:75], v[88:91], v[48:51]
  ds_read_b64_tr_b16 v[104:105], v242 offset:8192
  v_mfma_f32_16x16x32_bf16 v[56:59], v[72:75], v[92:95], v[56:59]
  ds_read_b64_tr_b16 v[106:107], v242 offset:9216
  v_mfma_f32_16x16x32_bf16 v[36:39], v[76:79], v[80:83], v[36:39]
  ds_read_b64_tr_b16 v[108:109], v243 offset:8192
  v_mfma_f32_16x16x32_bf16 v[44:47], v[76:79], v[84:87], v[44:47]
  ds_read_b64_tr_b16 v[110:111], v243 offset:9216
  v_mfma_f32_16x16x32_bf16 v[52:55], v[76:79], v[88:91], v[52:55]
  v_mfma_f32_16x16x32_bf16 v[60:63], v[76:79], v[92:95], v[60:63]
  s_waitcnt lgkmcnt(6)
  v_mfma_f32_16x16x32_bf16 v[0:3], v[96:99], v[112:115], v[0:3]
  v_mfma_f32_16x16x32_bf16 v[8:11], v[96:99], v[116:119], v[8:11]
  s_waitcnt lgkmcnt(0)
  s_barrier
  v_mfma_f32_16x16x32_bf16 v[16:19], v[96:99], v[120:123], v[16:19]
  ds_read_b64_tr_b16 v[64:65], v240 offset:32768
  v_mfma_f32_16x16x32_bf16 v[24:27], v[96:99], v[124:127], v[24:27]
  ds_read_b64_tr_b16 v[66:67], v240 offset:33792
  v_mfma_f32_16x16x32_bf16 v[4:7], v[100:103], v[112:115], v[4:7]
  ds_read_b128 v[80:83], v236 offset:32768
  v_mfma_f32_16x16x32_bf16 v[12:15], v[100:103], v[116:119], v[12:15]
  ds_read_b128 v[84:87], v236 offset:34816
  v_mfma_f32_16x16x32_bf16 v[20:23], v[100:103], v[120:123], v[20:23]
  ds_read_b128 v[88:91], v236 offset:36864
  v_mfma_f32_16x16x32_bf16 v[28:31], v[100:103], v[124:127], v[28:31]
  ds_read_b128 v[92:95], v236 offset:38912
  v_mfma_f32_16x16x32_bf16 v[32:35], v[104:107], v[112:115], v[32:35]
  ds_read_b64_tr_b16 v[68:69], v241 offset:32768
  v_mfma_f32_16x16x32_bf16 v[40:43], v[104:107], v[116:119], v[40:43]
  ds_read_b64_tr_b16 v[70:71], v241 offset:33792
  v_mfma_f32_16x16x32_bf16 v[48:51], v[104:107], v[120:123], v[48:51]
  ds_read_b64_tr_b16 v[72:73], v242 offset:32768
  v_mfma_f32_16x16x32_bf16 v[56:59], v[104:107], v[124:127], v[56:59]
  ds_read_b64_tr_b16 v[74:75], v242 offset:33792
  v_mfma_f32_16x16x32_bf16 v[36:39], v[108:111], v[112:115], v[36:39]
  ds_read_b64_tr_b16 v[76:77], v243 offset:32768
  v_mfma_f32_16x16x32_bf16 v[44:47], v[108:111], v[116:119], v[44:47]
  ds_read_b64_tr_b16 v[78:79], v243 offset:33792
  v_mfma_f32_16x16x32_bf16 v[52:55], v[108:111], v[120:123], v[52:55]
  v_mfma_f32_16x16x32_bf16 v[60:63], v[108:111], v[124:127], v[60:63]
  s_waitcnt lgkmcnt(6)
  v_mfma_f32_16x16x32_bf16 v[0:3], v[64:67], v[80:83], v[0:3]
  v_mfma_f32_16x16x32_bf16 v[8:11], v[64:67], v[84:87], v[8:11]
  s_waitcnt lgkmcnt(0)
  v_mfma_f32_16x16x32_bf16 v[16:19], v[64:67], v[88:91], v[16:19]
  ds_read_b64_tr_b16 v[96:97], v240 offset:40960
  v_mfma_f32_16x16x32_bf16 v[24:27], v[64:67], v[92:95], v[24:27]
  ds_read_b64_tr_b16 v[98:99], v240 offset:41984
  v_mfma_f32_16x16x32_bf16 v[4:7], v[68:71], v[80:83], v[4:7]
  ds_read_b128 v[112:115], v237 offset:32768
  v_mfma_f32_16x16x32_bf16 v[12:15], v[68:71], v[84:87], v[12:15]
  ds_read_b128 v[116:119], v237 offset:34816
  v_mfma_f32_16x16x32_bf16 v[20:23], v[68:71], v[88:91], v[20:23]
  ds_read_b128 v[120:123], v237 offset:36864
  v_mfma_f32_16x16x32_bf16 v[28:31], v[68:71], v[92:95], v[28:31]
  ds_read_b128 v[124:127], v237 offset:38912
  v_mfma_f32_16x16x32_bf16 v[32:35], v[72:75], v[80:83], v[32:35]
  ds_read_b64_tr_b16 v[100:101], v241 offset:40960
  v_mfma_f32_16x16x32_bf16 v[40:43], v[72:75], v[84:87], v[40:43]
  ds_read_b64_tr_b16 v[102:103], v241 offset:41984
  v_mfma_f32_16x16x32_bf16 v[48:51], v[72:75], v[88:91], v[48:51]
  ds_read_b64_tr_b16 v[104:105], v242 offset:40960
  v_mfma_f32_16x16x32_bf16 v[56:59], v[72:75], v[92:95], v[56:59]
  ds_read_b64_tr_b16 v[106:107], v242 offset:41984
  v_mfma_f32_16x16x32_bf16 v[36:39], v[76:79], v[80:83], v[36:39]
  ds_read_b64_tr_b16 v[108:109], v243 offset:40960
  v_mfma_f32_16x16x32_bf16 v[44:47], v[76:79], v[84:87], v[44:47]
  ds_read_b64_tr_b16 v[110:111], v243 offset:41984
  v_mfma_f32_16x16x32_bf16 v[52:55], v[76:79], v[88:91], v[52:55]
  v_mfma_f32_16x16x32_bf16 v[60:63], v[76:79], v[92:95], v[60:63]
  s_waitcnt lgkmcnt(6)
  v_mfma_f32_16x16x32_bf16 v[0:3], v[96:99], v[112:115], v[0:3]
  v_mfma_f32_16x16x32_bf16 v[8:11], v[96:99], v[116:119], v[8:11]
  s_waitcnt lgkmcnt(0)
  s_barrier
  v_mfma_f32_16x16x32_bf16 v[16:19], v[96:99], v[120:123], v[16:19]
  ds_read_b64_tr_b16 v[64:65], v244 offset:0
  v_mfma_f32_16x16x32_bf16 v[24:27], v[96:99], v[124:127], v[24:27]
  ds_read_b64_tr_b16 v[66:67], v244 offset:1024
  v_mfma_f32_16x16x32_bf16 v[4:7], v[100:103], v[112:115], v[4:7]
  ds_read_b128 v[80:83], v238 offset:0
  v_mfma_f32_16x16x32_bf16 v[12:15], v[100:103], v[116:119], v[12:15]
  ds_read_b128 v[84:87], v238 offset:2048
  v_mfma_f32_16x16x32_bf16 v[20:23], v[100:103], v[120:123], v[20:23]
  ds_read_b128 v[88:91], v238 offset:4096
  v_mfma_f32_16x16x32_bf16 v[28:31], v[100:103], v[124:127], v[28:31]
  ds_read_b128 v[92:95], v238 offset:6144
  v_mfma_f32_16x16x32_bf16 v[32:35], v[104:107], v[112:115], v[32:35]
  ds_read_b64_tr_b16 v[68:69], v245 offset:0
  v_mfma_f32_16x16x32_bf16 v[40:43], v[104:107], v[116:119], v[40:43]
  ds_read_b64_tr_b16 v[70:71], v245 offset:1024
  v_mfma_f32_16x16x32_bf16 v[48:51], v[104:107], v[120:123], v[48:51]
  ds_read_b64_tr_b16 v[72:73], v246 offset:0
  v_mfma_f32_16x16x32_bf16 v[56:59], v[104:107], v[124:127], v[56:59]
  ds_read_b64_tr_b16 v[74:75], v246 offset:1024
  v_mfma_f32_16x16x32_bf16 v[36:39], v[108:111], v[112:115], v[36:39]
  ds_read_b64_tr_b16 v[76:77], v247 offset:0
  v_mfma_f32_16x16x32_bf16 v[44:47], v[108:111], v[116:119], v[44:47]
  ds_read_b64_tr_b16 v[78:79], v247 offset:1024
  v_mfma_f32_16x16x32_bf16 v[52:55], v[108:111], v[120:123], v[52:55]
  v_mfma_f32_16x16x32_bf16 v[60:63], v[108:111], v[124:127], v[60:63]
  s_waitcnt lgkmcnt(6)
  v_mfma_f32_16x16x32_bf16 v[0:3], v[64:67], v[80:83], v[0:3]
  v_mfma_f32_16x16x32_bf16 v[8:11], v[64:67], v[84:87], v[8:11]
  s_waitcnt lgkmcnt(0)
  v_mfma_f32_16x16x32_bf16 v[16:19], v[64:67], v[88:91], v[16:19]
  ds_read_b64_tr_b16 v[96:97], v244 offset:8192
  v_mfma_f32_16x16x32_bf16 v[24:27], v[64:67], v[92:95], v[24:27]
  ds_read_b64_tr_b16 v[98:99], v244 offset:9216
  v_mfma_f32_16x16x32_bf16 v[4:7], v[68:71], v[80:83], v[4:7]
  ds_read_b128 v[112:115], v239 offset:0
  v_mfma_f32_16x16x32_bf16 v[12:15], v[68:71], v[84:87], v[12:15]
  ds_read_b128 v[116:119], v239 offset:2048
  v_mfma_f32_16x16x32_bf16 v[20:23], v[68:71], v[88:91], v[20:23]
  ds_read_b128 v[120:123], v239 offset:4096
  v_mfma_f32_16x16x32_bf16 v[28:31], v[68:71], v[92:95], v[28:31]
  ds_read_b128 v[124:127], v239 offset:6144
  v_mfma_f32_16x16x32_bf16 v[32:35], v[72:75], v[80:83], v[32:35]
  ds_read_b64_tr_b16 v[100:101], v245 offset:8192
  v_mfma_f32_16x16x32_bf16 v[40:43], v[72:75], v[84:87], v[40:43]
  ds_read_b64_tr_b16 v[102:103], v245 offset:9216
  v_mfma_f32_16x16x32_bf16 v[48:51], v[72:75], v[88:91], v[48:51]
  ds_read_b64_tr_b16 v[104:105], v246 offset:8192
  v_mfma_f32_16x16x32_bf16 v[56:59], v[72:75], v[92:95], v[56:59]
  ds_read_b64_tr_b16 v[106:107], v246 offset:9216
  v_mfma_f32_16x16x32_bf16 v[36:39], v[76:79], v[80:83], v[36:39]
  ds_read_b64_tr_b16 v[108:109], v247 offset:8192
  v_mfma_f32_16x16x32_bf16 v[44:47], v[76:79], v[84:87], v[44:47]
  ds_read_b64_tr_b16 v[110:111], v247 offset:9216
  v_mfma_f32_16x16x32_bf16 v[52:55], v[76:79], v[88:91], v[52:55]
  v_mfma_f32_16x16x32_bf16 v[60:63], v[76:79], v[92:95], v[60:63]
  s_waitcnt lgkmcnt(6)
  v_mfma_f32_16x16x32_bf16 v[0:3], v[96:99], v[112:115], v[0:3]
  v_mfma_f32_16x16x32_bf16 v[8:11], v[96:99], v[116:119], v[8:11]
  s_waitcnt lgkmcnt(0)
  s_barrier
  v_mfma_f32_16x16x32_bf16 v[16:19], v[96:99], v[120:123], v[16:19]
  ds_read_b64_tr_b16 v[64:65], v244 offset:32768
  v_mfma_f32_16x16x32_bf16 v[24:27], v[96:99], v[124:127], v[24:27]
  ds_read_b64_tr_b16 v[66:67], v244 offset:33792
  v_mfma_f32_16x16x32_bf16 v[4:7], v[100:103], v[112:115], v[4:7]
  ds_read_b128 v[80:83], v238 offset:32768
  v_mfma_f32_16x16x32_bf16 v[12:15], v[100:103], v[116:119], v[12:15]
  ds_read_b128 v[84:87], v238 offset:34816
  v_mfma_f32_16x16x32_bf16 v[20:23], v[100:103], v[120:123], v[20:23]
  ds_read_b128 v[88:91], v238 offset:36864
  v_mfma_f32_16x16x32_bf16 v[28:31], v[100:103], v[124:127], v[28:31]
  ds_read_b128 v[92:95], v238 offset:38912
  v_mfma_f32_16x16x32_bf16 v[32:35], v[104:107], v[112:115], v[32:35]
  ds_read_b64_tr_b16 v[68:69], v245 offset:32768
  v_mfma_f32_16x16x32_bf16 v[40:43], v[104:107], v[116:119], v[40:43]
  ds_read_b64_tr_b16 v[70:71], v245 offset:33792
  v_mfma_f32_16x16x32_bf16 v[48:51], v[104:107], v[120:123], v[48:51]
  ds_read_b64_tr_b16 v[72:73], v246 offset:32768
  v_mfma_f32_16x16x32_bf16 v[56:59], v[104:107], v[124:127], v[56:59]
  ds_read_b64_tr_b16 v[74:75], v246 offset:33792
  v_mfma_f32_16x16x32_bf16 v[36:39], v[108:111], v[112:115], v[36:39]
  ds_read_b64_tr_b16 v[76:77], v247 offset:32768
  v_mfma_f32_16x16x32_bf16 v[44:47], v[108:111], v[116:119], v[44:47]
  ds_read_b64_tr_b16 v[78:79], v247 offset:33792
  v_mfma_f32_16x16x32_bf16 v[52:55], v[108:111], v[120:123], v[52:55]
  v_mfma_f32_16x16x32_bf16 v[60:63], v[108:111], v[124:127], v[60:63]
  s_waitcnt lgkmcnt(6)
  v_mfma_f32_16x16x32_bf16 v[0:3], v[64:67], v[80:83], v[0:3]
  v_mfma_f32_16x16x32_bf16 v[8:11], v[64:67], v[84:87], v[8:11]
  s_waitcnt lgkmcnt(0)
  v_mfma_f32_16x16x32_bf16 v[16:19], v[64:67], v[88:91], v[16:19]
  ds_read_b64_tr_b16 v[96:97], v244 offset:40960
  v_mfma_f32_16x16x32_bf16 v[24:27], v[64:67], v[92:95], v[24:27]
  ds_read_b64_tr_b16 v[98:99], v244 offset:41984
  v_mfma_f32_16x16x32_bf16 v[4:7], v[68:71], v[80:83], v[4:7]
  ds_read_b128 v[112:115], v239 offset:32768
  v_mfma_f32_16x16x32_bf16 v[12:15], v[68:71], v[84:87], v[12:15]
  ds_read_b128 v[116:119], v239 offset:34816
  v_mfma_f32_16x16x32_bf16 v[20:23], v[68:71], v[88:91], v[20:23]
  ds_read_b128 v[120:123], v239 offset:36864
  v_mfma_f32_16x16x32_bf16 v[28:31], v[68:71], v[92:95], v[28:31]
L_warm_a0:
  s_cbranch_execz L_warm_a1
  s_nop 0
  ds_read_b128 v[124:127], v239 offset:38912
  v_mfma_f32_16x16x32_bf16 v[32:35], v[72:75], v[80:83], v[32:35]
  ds_read_b64_tr_b16 v[100:101], v245 offset:40960
  v_mfma_f32_16x16x32_bf16 v[40:43], v[72:75], v[84:87], v[40:43]
  ds_read_b64_tr_b16 v[102:103], v245 offset:41984
  v_mfma_f32_16x16x32_bf16 v[48:51], v[72:75], v[88:91], v[48:51]
  ds_read_b64_tr_b16 v[104:105], v246 offset:40960
  v_mfma_f32_16x16x32_bf16 v[56:59], v[72:75], v[92:95], v[56:59]
  ds_read_b64_tr_b16 v[106:107], v246 offset:41984
  v_mfma_f32_16x16x32_bf16 v[36:39], v[76:79], v[80:83], v[36:39]
  ds_read_b64_tr_b16 v[108:109], v247 offset:40960
  v_mfma_f32_16x16x32_bf16 v[44:47], v[76:79], v[84:87], v[44:47]
  ds_read_b64_tr_b16 v[110:111], v247 offset:41984
  v_mfma_f32_16x16x32_bf16 v[52:55], v[76:79], v[88:91], v[52:55]
  v_mfma_f32_16x16x32_bf16 v[60:63], v[76:79], v[92:95], v[60:63]
  s_waitcnt lgkmcnt(6)
  v_mfma_f32_16x16x32_bf16 v[0:3], v[96:99], v[112:115], v[0:3]
  v_mfma_f32_16x16x32_bf16 v[8:11], v[96:99], v[116:119], v[8:11]
  s_waitcnt lgkmcnt(0)
  s_barrier
  v_mfma_f32_16x16x32_bf16 v[16:19], v[96:99], v[120:123], v[16:19]
  ds_read_b128 v[200:203], v230 offset:0
  v_mfma_f32_16x16x32_bf16 v[24:27], v[96:99], v[124:127], v[24:27]
  ds_read_b128 v[204:207], v230 offset:256
  v_mfma_f32_16x16x32_bf16 v[4:7], v[100:103], v[112:115], v[4:7]
  ds_read_b128 v[208:211], v230 offset:512
  v_mfma_f32_16x16x32_bf16 v[12:15], v[100:103], v[116:119], v[12:15]
  ds_read_b128 v[212:215], v230 offset:768
  v_mfma_f32_16x16x32_bf16 v[20:23], v[100:103], v[120:123], v[20:23]
  ds_read_b64 v[192:193], v231 offset:0
  v_mfma_f32_16x16x32_bf16 v[28:31], v[100:103], v[124:127], v[28:31]
  ds_read_b64 v[194:195], v231 offset:128
  v_mfma_f32_16x16x32_bf16 v[32:35], v[104:107], v[112:115], v[32:35]
  ds_read_b64 v[196:197], v231 offset:256
  v_mfma_f32_16x16x32_bf16 v[40:43], v[104:107], v[116:119], v[40:43]
  ds_read_b64 v[198:199], v231 offset:384
  v_mfma_f32_16x16x32_bf16 v[48:51], v[104:107], v[120:123], v[48:51]
  s_add_u32 s62, s73, 4096
  v_mfma_f32_16x16x32_bf16 v[56:59], v[104:107], v[124:127], v[56:59]
  s_mov_b32 s25, 1
  v_mfma_f32_16x16x32_bf16 v[36:39], v[108:111], v[112:115], v[36:39]
  v_mfma_f32_16x16x32_bf16 v[44:47], v[108:111], v[116:119], v[44:47]
  v_mfma_f32_16x16x32_bf16 v[52:55], v[108:111], v[120:123], v[52:55]
  v_mfma_f32_16x16x32_bf16 v[60:63], v[108:111], v[124:127], v[60:63]
  s_waitcnt lgkmcnt(0)
  v_mfma_f32_4x4x4_16b_bf16 v[0:3], v[192:193], v[200:201], v[0:3]
  v_mfma_f32_4x4x4_16b_bf16 v[8:11], v[192:193], v[204:205], v[8:11]
  v_mfma_f32_4x4x4_16b_bf16 v[16:19], v[192:193], v[208:209], v[16:19]
  v_mfma_f32_4x4x4_16b_bf16 v[24:27], v[192:193], v[212:213], v[24:27]
  v_mfma_f32_4x4x4_16b_bf16 v[4:7], v[194:195], v[200:201], v[4:7]
  v_mfma_f32_4x4x4_16b_bf16 v[12:15], v[194:195], v[204:205], v[12:15]
  v_mfma_f32_4x4x4_16b_bf16 v[20:23], v[194:195], v[208:209], v[20:23]
  v_mfma_f32_4x4x4_16b_bf16 v[28:31], v[194:195], v[212:213], v[28:31]
  v_mfma_f32_4x4x4_16b_bf16 v[32:35], v[196:197], v[200:201], v[32:35]
  v_mfma_f32_4x4x4_16b_bf16 v[40:43], v[196:197], v[204:205], v[40:43]
  v_mfma_f32_4x4x4_16b_bf16 v[48:51], v[196:197], v[208:209], v[48:51]
  v_mfma_f32_4x4x4_16b_bf16 v[56:59], v[196:197], v[212:213], v[56:59]
  v_mfma_f32_4x4x4_16b_bf16 v[36:39], v[198:199], v[200:201], v[36:39]
  v_mfma_f32_4x4x4_16b_bf16 v[44:47], v[198:199], v[204:205], v[44:47]
  v_mfma_f32_4x4x4_16b_bf16 v[52:55], v[198:199], v[208:209], v[52:55]
  v_mfma_f32_4x4x4_16b_bf16 v[60:63], v[198:199], v[212:213], v[60:63]
  v_and_b32 v201, 0xffff0000, v201
  v_and_b32 v205, 0xffff0000, v205
  v_and_b32 v209, 0xffff0000, v209
  v_and_b32 v213, 0xffff0000, v213
.p2align 3
  v_pk_mul_f32 v[176:177], v[0:1], v[0:1]
  v_pk_mul_f32 v[178:179], v[2:3], v[2:3]
  v_pk_mul_f32 v[180:181], v[4:5], v[4:5]
  v_pk_mul_f32 v[182:183], v[6:7], v[6:7]
  v_pk_fma_f32 v[176:177], v[176:177], v[202:203], v[202:203] op_sel:[0,1,0] op_sel_hi:[1,1,0]
  v_pk_fma_f32 v[178:179], v[178:179], v[202:203], v[202:203] op_sel:[0,1,0] op_sel_hi:[1,1,0]
  v_pk_fma_f32 v[180:181], v[180:181], v[202:203], v[202:203] op_sel:[0,1,0] op_sel_hi:[1,1,0]
  v_pk_fma_f32 v[182:183], v[182:183], v[202:203], v[202:203] op_sel:[0,1,0] op_sel_hi:[1,1,0]
  v_pk_mul_f32 v[176:177], v[176:177], v[0:1]
  v_pk_mul_f32 v[178:179], v[178:179], v[2:3]
  v_pk_mul_f32 v[180:181], v[180:181], v[4:5]
  v_pk_mul_f32 v[182:183], v[182:183], v[6:7]
  v_exp_f32 v176, v176
  v_exp_f32 v177, v177
  v_exp_f32 v178, v178
  v_exp_f32 v179, v179
  v_exp_f32 v180, v180
  v_exp_f32 v181, v181
  v_exp_f32 v182, v182
  v_exp_f32 v183, v183
  v_pk_fma_f32 v[176:177], v[176:177], v[200:201], v[200:201] op_sel:[0,1,1] op_sel_hi:[1,1,1]
  v_pk_fma_f32 v[178:179], v[178:179], v[200:201], v[200:201] op_sel:[0,1,1] op_sel_hi:[1,1,1]
  v_pk_fma_f32 v[180:181], v[180:181], v[200:201], v[200:201] op_sel:[0,1,1] op_sel_hi:[1,1,1]
  v_pk_fma_f32 v[182:183], v[182:183], v[200:201], v[200:201] op_sel:[0,1,1] op_sel_hi:[1,1,1]
  v_rcp_f32 v176, v176
  v_rcp_f32 v177, v177
  v_rcp_f32 v178, v178
  v_rcp_f32 v179, v179
  v_rcp_f32 v180, v180
  v_rcp_f32 v181, v181
  v_rcp_f32 v182, v182
  v_rcp_f32 v183, v183
  v_pk_mul_f32 v[176:177], v[176:177], v[0:1]
  v_pk_mul_f32 v[178:179], v[178:179], v[2:3]
  v_pk_mul_f32 v[180:181], v[180:181], v[4:5]
  v_pk_mul_f32 v[182:183], v[182:183], v[6:7]
  v_cvt_pk_bf16_f32 v0, v176, v177
  v_cvt_pk_bf16_f32 v1, v178, v179
  v_cvt_pk_bf16_f32 v2, v180, v181
  v_cvt_pk_bf16_f32 v3, v182, v183
  v_pk_mul_f32 v[176:177], v[8:9], v[8:9]
  v_pk_mul_f32 v[178:179], v[10:11], v[10:11]
  v_pk_mul_f32 v[180:181], v[12:13], v[12:13]
  v_pk_mul_f32 v[182:183], v[14:15], v[14:15]
  v_pk_fma_f32 v[176:177], v[176:177], v[206:207], v[206:207] op_sel:[0,1,0] op_sel_hi:[1,1,0]
  v_pk_fma_f32 v[178:179], v[178:179], v[206:207], v[206:207] op_sel:[0,1,0] op_sel_hi:[1,1,0]
  v_pk_fma_f32 v[180:181], v[180:181], v[206:207], v[206:207] op_sel:[0,1,0] op_sel_hi:[1,1,0]
  v_pk_fma_f32 v[182:183], v[182:183], v[206:207], v[206:207] op_sel:[0,1,0] op_sel_hi:[1,1,0]
  v_pk_mul_f32 v[176:177], v[176:177], v[8:9]
  v_pk_mul_f32 v[178:179], v[178:179], v[10:11]
  v_pk_mul_f32 v[180:181], v[180:181], v[12:13]
  v_pk_mul_f32 v[182:183], v[182:183], v[14:15]
  v_exp_f32 v176, v176
  v_exp_f32 v177, v177
  v_exp_f32 v178, v178
  v_exp_f32 v179, v179
  v_exp_f32 v180, v180
  v_exp_f32 v181, v181
  v_exp_f32 v182, v182
  v_exp_f32 v183, v183
  v_pk_fma_f32 v[176:177], v[176:177], v[204:205], v[204:205] op_sel:[0,1,1] op_sel_hi:[1,1,1]
  v_pk_fma_f32 v[178:179], v[178:179], v[204:205], v[204:205] op_sel:[0,1,1] op_sel_hi:[1,1,1]
  v_pk_fma_f32 v[180:181], v[180:181], v[204:205], v[204:205] op_sel:[0,1,1] op_sel_hi:[1,1,1]
  v_pk_fma_f32 v[182:183], v[182:183], v[204:205], v[204:205] op_sel:[0,1,1] op_sel_hi:[1,1,1]
  v_rcp_f32 v176, v176
  v_rcp_f32 v177, v177
  v_rcp_f32 v178, v178
  v_rcp_f32 v179, v179
  v_rcp_f32 v180, v180
  v_rcp_f32 v181, v181
  v_rcp_f32 v182, v182
  v_rcp_f32 v183, v183
  v_pk_mul_f32 v[176:177], v[176:177], v[8:9]
  v_pk_mul_f32 v[178:179], v[178:179], v[10:11]
  v_pk_mul_f32 v[180:181], v[180:181], v[12:13]
  v_pk_mul_f32 v[182:183], v[182:183], v[14:15]
  v_cvt_pk_bf16_f32 v8, v176, v177
  v_cvt_pk_bf16_f32 v9, v178, v179
  v_cvt_pk_bf16_f32 v10, v180, v181
  v_cvt_pk_bf16_f32 v11, v182, v183
  buffer_store_dwordx4 v[0:3], v252, s[48:51], s73 offen offset:0 sc1
  buffer_store_dwordx4 v[8:11], v252, s[48:51], s73 offen offset:1024 sc1
  v_pk_mul_f32 v[176:177], v[16:17], v[16:17]
  v_pk_mul_f32 v[178:179], v[18:19], v[18:19]
  v_pk_mul_f32 v[180:181], v[20:21], v[20:21]
  v_pk_mul_f32 v[182:183], v[22:23], v[22:23]
  v_pk_fma_f32 v[176:177], v[176:177], v[210:211], v[210:211] op_sel:[0,1,0] op_sel_hi:[1,1,0]
  v_pk_fma_f32 v[178:179], v[178:179], v[210:211], v[210:211] op_sel:[0,1,0] op_sel_hi:[1,1,0]
  v_pk_fma_f32 v[180:181], v[180:181], v[210:211], v[210:211] op_sel:[0,1,0] op_sel_hi:[1,1,0]
  v_pk_fma_f32 v[182:183], v[182:183], v[210:211], v[210:211] op_sel:[0,1,0] op_sel_hi:[1,1,0]
  v_pk_mul_f32 v[176:177], v[176:177], v[16:17]
  v_pk_mul_f32 v[178:179], v[178:179], v[18:19]
  v_pk_mul_f32 v[180:181], v[180:181], v[20:21]
  v_pk_mul_f32 v[182:183], v[182:183], v[22:23]
  v_exp_f32 v176, v176
  v_exp_f32 v177, v177
  v_exp_f32 v178, v178
  v_exp_f32 v179, v179
  v_exp_f32 v180, v180
  v_exp_f32 v181, v181
  v_exp_f32 v182, v182
  v_exp_f32 v183, v183
  v_pk_fma_f32 v[176:177], v[176:177], v[208:209], v[208:209] op_sel:[0,1,1] op_sel_hi:[1,1,1]
  v_pk_fma_f32 v[178:179], v[178:179], v[208:209], v[208:209] op_sel:[0,1,1] op_sel_hi:[1,1,1]
  v_pk_fma_f32 v[180:181], v[180:181], v[208:209], v[208:209] op_sel:[0,1,1] op_sel_hi:[1,1,1]
  v_pk_fma_f32 v[182:183], v[182:183], v[208:209], v[208:209] op_sel:[0,1,1] op_sel_hi:[1,1,1]
  v_rcp_f32 v176, v176
  v_rcp_f32 v177, v177
  v_rcp_f32 v178, v178
  v_rcp_f32 v179, v179
  v_rcp_f32 v180, v180
  v_rcp_f32 v181, v181
  v_rcp_f32 v182, v182
  v_rcp_f32 v183, v183
  v_pk_mul_f32 v[176:177], v[176:177], v[16:17]
  v_pk_mul_f32 v[178:179], v[178:179], v[18:19]
  v_pk_mul_f32 v[180:181], v[180:181], v[20:21]
  v_pk_mul_f32 v[182:183], v[182:183], v[22:23]
  v_cvt_pk_bf16_f32 v16, v176, v177
  v_cvt_pk_bf16_f32 v17, v178, v179
  v_cvt_pk_bf16_f32 v18, v180, v181
  v_cvt_pk_bf16_f32 v19, v182, v183
  v_pk_mul_f32 v[176:177], v[24:25], v[24:25]
  v_pk_mul_f32 v[178:179], v[26:27], v[26:27]
  v_pk_mul_f32 v[180:181], v[28:29], v[28:29]
  v_pk_mul_f32 v[182:183], v[30:31], v[30:31]
  v_pk_fma_f32 v[176:177], v[176:177], v[214:215], v[214:215] op_sel:[0,1,0] op_sel_hi:[1,1,0]
  v_pk_fma_f32 v[178:179], v[178:179], v[214:215], v[214:215] op_sel:[0,1,0] op_sel_hi:[1,1,0]
  v_pk_fma_f32 v[180:181], v[180:181], v[214:215], v[214:215] op_sel:[0,1,0] op_sel_hi:[1,1,0]
  v_pk_fma_f32 v[182:183], v[182:183], v[214:215], v[214:215] op_sel:[0,1,0] op_sel_hi:[1,1,0]
  v_pk_mul_f32 v[176:177], v[176:177], v[24:25]
  v_pk_mul_f32 v[178:179], v[178:179], v[26:27]
  v_pk_mul_f32 v[180:181], v[180:181], v[28:29]
  v_pk_mul_f32 v[182:183], v[182:183], v[30:31]
  v_exp_f32 v176, v176
  v_exp_f32 v177, v177
  v_exp_f32 v178, v178
  v_exp_f32 v179, v179
  v_exp_f32 v180, v180
  v_exp_f32 v181, v181
  v_exp_f32 v182, v182
  v_exp_f32 v183, v183
  v_pk_fma_f32 v[176:177], v[176:177], v[212:213], v[212:213] op_sel:[0,1,1] op_sel_hi:[1,1,1]
  v_pk_fma_f32 v[178:179], v[178:179], v[212:213], v[212:213] op_sel:[0,1,1] op_sel_hi:[1,1,1]
  v_pk_fma_f32 v[180:181], v[180:181], v[212:213], v[212:213] op_sel:[0,1,1] op_sel_hi:[1,1,1]
  v_pk_fma_f32 v[182:183], v[182:183], v[212:213], v[212:213] op_sel:[0,1,1] op_sel_hi:[1,1,1]
  v_rcp_f32 v176, v176
  v_rcp_f32 v177, v177
  v_rcp_f32 v178, v178
  v_rcp_f32 v179, v179
  v_rcp_f32 v180, v180
  v_rcp_f32 v181, v181
  v_rcp_f32 v182, v182
  v_rcp_f32 v183, v183
  v_pk_mul_f32 v[176:177], v[176:177], v[24:25]
  v_pk_mul_f32 v[178:179], v[178:179], v[26:27]
  v_pk_mul_f32 v[180:181], v[180:181], v[28:29]
  v_pk_mul_f32 v[182:183], v[182:183], v[30:31]
  v_cvt_pk_bf16_f32 v24, v176, v177
  v_cvt_pk_bf16_f32 v25, v178, v179
  v_cvt_pk_bf16_f32 v26, v180, v181
  v_cvt_pk_bf16_f32 v27, v182, v183
  buffer_store_dwordx4 v[16:19], v252, s[48:51], s73 offen offset:2048 sc1
  buffer_store_dwordx4 v[24:27], v252, s[48:51], s73 offen offset:3072 sc1
  v_pk_mul_f32 v[176:177], v[32:33], v[32:33]
  v_pk_mul_f32 v[178:179], v[34:35], v[34:35]
  v_pk_mul_f32 v[180:181], v[36:37], v[36:37]
  v_pk_mul_f32 v[182:183], v[38:39], v[38:39]
  v_pk_fma_f32 v[176:177], v[176:177], v[202:203], v[202:203] op_sel:[0,1,0] op_sel_hi:[1,1,0]
  v_pk_fma_f32 v[178:179], v[178:179], v[202:203], v[202:203] op_sel:[0,1,0] op_sel_hi:[1,1,0]
  v_pk_fma_f32 v[180:181], v[180:181], v[202:203], v[202:203] op_sel:[0,1,0] op_sel_hi:[1,1,0]
  v_pk_fma_f32 v[182:183], v[182:183], v[202:203], v[202:203] op_sel:[0,1,0] op_sel_hi:[1,1,0]
  v_pk_mul_f32 v[176:177], v[176:177], v[32:33]
  v_pk_mul_f32 v[178:179], v[178:179], v[34:35]
  v_pk_mul_f32 v[180:181], v[180:181], v[36:37]
  v_pk_mul_f32 v[182:183], v[182:183], v[38:39]
  v_exp_f32 v176, v176
  v_exp_f32 v177, v177
  v_exp_f32 v178, v178
  v_exp_f32 v179, v179
  v_exp_f32 v180, v180
  v_exp_f32 v181, v181
  v_exp_f32 v182, v182
  v_exp_f32 v183, v183
  v_pk_fma_f32 v[176:177], v[176:177], v[200:201], v[200:201] op_sel:[0,1,1] op_sel_hi:[1,1,1]
  v_pk_fma_f32 v[178:179], v[178:179], v[200:201], v[200:201] op_sel:[0,1,1] op_sel_hi:[1,1,1]
  v_pk_fma_f32 v[180:181], v[180:181], v[200:201], v[200:201] op_sel:[0,1,1] op_sel_hi:[1,1,1]
  v_pk_fma_f32 v[182:183], v[182:183], v[200:201], v[200:201] op_sel:[0,1,1] op_sel_hi:[1,1,1]
  v_rcp_f32 v176, v176
  v_rcp_f32 v177, v177
  v_rcp_f32 v178, v178
  v_rcp_f32 v179, v179
  v_rcp_f32 v180, v180
  v_rcp_f32 v181, v181
  v_rcp_f32 v182, v182
  v_rcp_f32 v183, v183
  v_pk_mul_f32 v[176:177], v[176:177], v[32:33]
  v_pk_mul_f32 v[178:179], v[178:179], v[34:35]
  v_pk_mul_f32 v[180:181], v[180:181], v[36:37]
  v_pk_mul_f32 v[182:183], v[182:183], v[38:39]
  v_cvt_pk_bf16_f32 v32, v176, v177
  v_cvt_pk_bf16_f32 v33, v178, v179
  v_cvt_pk_bf16_f32 v34, v180, v181
  v_cvt_pk_bf16_f32 v35, v182, v183
  v_pk_mul_f32 v[176:177], v[40:41], v[40:41]
  v_pk_mul_f32 v[178:179], v[42:43], v[42:43]
  v_pk_mul_f32 v[180:181], v[44:45], v[44:45]
  v_pk_mul_f32 v[182:183], v[46:47], v[46:47]
  v_pk_fma_f32 v[176:177], v[176:177], v[206:207], v[206:207] op_sel:[0,1,0] op_sel_hi:[1,1,0]
  v_pk_fma_f32 v[178:179], v[178:179], v[206:207], v[206:207] op_sel:[0,1,0] op_sel_hi:[1,1,0]
  v_pk_fma_f32 v[180:181], v[180:181], v[206:207], v[206:207] op_sel:[0,1,0] op_sel_hi:[1,1,0]
  v_pk_fma_f32 v[182:183], v[182:183], v[206:207], v[206:207] op_sel:[0,1,0] op_sel_hi:[1,1,0]
  v_pk_mul_f32 v[176:177], v[176:177], v[40:41]
  v_pk_mul_f32 v[178:179], v[178:179], v[42:43]
  v_pk_mul_f32 v[180:181], v[180:181], v[44:45]
  v_pk_mul_f32 v[182:183], v[182:183], v[46:47]
  v_exp_f32 v176, v176
  v_exp_f32 v177, v177
  v_exp_f32 v178, v178
  v_exp_f32 v179, v179
  v_exp_f32 v180, v180
  v_exp_f32 v181, v181
  v_exp_f32 v182, v182
  v_exp_f32 v183, v183
  v_pk_fma_f32 v[176:177], v[176:177], v[204:205], v[204:205] op_sel:[0,1,1] op_sel_hi:[1,1,1]
  v_pk_fma_f32 v[178:179], v[178:179], v[204:205], v[204:205] op_sel:[0,1,1] op_sel_hi:[1,1,1]
  v_pk_fma_f32 v[180:181], v[180:181], v[204:205], v[204:205] op_sel:[0,1,1] op_sel_hi:[1,1,1]
  v_pk_fma_f32 v[182:183], v[182:183], v[204:205], v[204:205] op_sel:[0,1,1] op_sel_hi:[1,1,1]
  v_rcp_f32 v176, v176
  v_rcp_f32 v177, v177
  v_rcp_f32 v178, v178
  v_rcp_f32 v179, v179
  v_rcp_f32 v180, v180
  v_rcp_f32 v181, v181
  v_rcp_f32 v182, v182
  v_rcp_f32 v183, v183
  v_pk_mul_f32 v[176:177], v[176:177], v[40:41]
  v_pk_mul_f32 v[178:179], v[178:179], v[42:43]
  v_pk_mul_f32 v[180:181], v[180:181], v[44:45]
  v_pk_mul_f32 v[182:183], v[182:183], v[46:47]
  v_cvt_pk_bf16_f32 v40, v176, v177
  v_cvt_pk_bf16_f32 v41, v178, v179
  v_cvt_pk_bf16_f32 v42, v180, v181
  v_cvt_pk_bf16_f32 v43, v182, v183
  buffer_store_dwordx4 v[32:35], v252, s[48:51], s62 offen offset:0 sc1
  buffer_store_dwordx4 v[40:43], v252, s[48:51], s62 offen offset:1024 sc1
  v_pk_mul_f32 v[176:177], v[48:49], v[48:49]
  v_pk_mul_f32 v[178:179], v[50:51], v[50:51]
  v_pk_mul_f32 v[180:181], v[52:53], v[52:53]
  v_pk_mul_f32 v[182:183], v[54:55], v[54:55]
  v_pk_fma_f32 v[176:177], v[176:177], v[210:211], v[210:211] op_sel:[0,1,0] op_sel_hi:[1,1,0]
  v_pk_fma_f32 v[178:179], v[178:179], v[210:211], v[210:211] op_sel:[0,1,0] op_sel_hi:[1,1,0]
  v_pk_fma_f32 v[180:181], v[180:181], v[210:211], v[210:211] op_sel:[0,1,0] op_sel_hi:[1,1,0]
  v_pk_fma_f32 v[182:183], v[182:183], v[210:211], v[210:211] op_sel:[0,1,0] op_sel_hi:[1,1,0]
  v_pk_mul_f32 v[176:177], v[176:177], v[48:49]
  v_pk_mul_f32 v[178:179], v[178:179], v[50:51]
  v_pk_mul_f32 v[180:181], v[180:181], v[52:53]
  v_pk_mul_f32 v[182:183], v[182:183], v[54:55]
  v_exp_f32 v176, v176
  v_exp_f32 v177, v177
  v_exp_f32 v178, v178
  v_exp_f32 v179, v179
  v_exp_f32 v180, v180
  v_exp_f32 v181, v181
  v_exp_f32 v182, v182
  v_exp_f32 v183, v183
  v_pk_fma_f32 v[176:177], v[176:177], v[208:209], v[208:209] op_sel:[0,1,1] op_sel_hi:[1,1,1]
  v_pk_fma_f32 v[178:179], v[178:179], v[208:209], v[208:209] op_sel:[0,1,1] op_sel_hi:[1,1,1]
  v_pk_fma_f32 v[180:181], v[180:181], v[208:209], v[208:209] op_sel:[0,1,1] op_sel_hi:[1,1,1]
  v_pk_fma_f32 v[182:183], v[182:183], v[208:209], v[208:209] op_sel:[0,1,1] op_sel_hi:[1,1,1]
  v_rcp_f32 v176, v176
  v_rcp_f32 v177, v177
  v_rcp_f32 v178, v178
  v_rcp_f32 v179, v179
  v_rcp_f32 v180, v180
  v_rcp_f32 v181, v181
  v_rcp_f32 v182, v182
  v_rcp_f32 v183, v183
  v_pk_mul_f32 v[176:177], v[176:177], v[48:49]
  v_pk_mul_f32 v[178:179], v[178:179], v[50:51]
  v_pk_mul_f32 v[180:181], v[180:181], v[52:53]
  v_pk_mul_f32 v[182:183], v[182:183], v[54:55]
  v_cvt_pk_bf16_f32 v48, v176, v177
  v_cvt_pk_bf16_f32 v49, v178, v179
  v_cvt_pk_bf16_f32 v50, v180, v181
  v_cvt_pk_bf16_f32 v51, v182, v183
  s_barrier
  s_nop 0
  v_pk_mul_f32 v[176:177], v[56:57], v[56:57]
  v_pk_mul_f32 v[178:179], v[58:59], v[58:59]
  v_pk_mul_f32 v[180:181], v[60:61], v[60:61]
  v_pk_mul_f32 v[182:183], v[62:63], v[62:63]
  v_pk_fma_f32 v[176:177], v[176:177], v[214:215], v[214:215] op_sel:[0,1,0] op_sel_hi:[1,1,0]
  v_pk_fma_f32 v[178:179], v[178:179], v[214:215], v[214:215] op_sel:[0,1,0] op_sel_hi:[1,1,0]
  v_pk_fma_f32 v[180:181], v[180:181], v[214:215], v[214:215] op_sel:[0,1,0] op_sel_hi:[1,1,0]
  v_pk_fma_f32 v[182:183], v[182:183], v[214:215], v[214:215] op_sel:[0,1,0] op_sel_hi:[1,1,0]
  v_pk_mul_f32 v[176:177], v[176:177], v[56:57]
  v_pk_mul_f32 v[178:179], v[178:179], v[58:59]
  v_pk_mul_f32 v[180:181], v[180:181], v[60:61]
  v_pk_mul_f32 v[182:183], v[182:183], v[62:63]
  v_exp_f32 v176, v176
  v_exp_f32 v177, v177
  v_exp_f32 v178, v178
  v_exp_f32 v179, v179
  v_exp_f32 v180, v180
  v_exp_f32 v181, v181
  v_exp_f32 v182, v182
  v_exp_f32 v183, v183
  v_pk_fma_f32 v[176:177], v[176:177], v[212:213], v[212:213] op_sel:[0,1,1] op_sel_hi:[1,1,1]
  v_pk_fma_f32 v[178:179], v[178:179], v[212:213], v[212:213] op_sel:[0,1,1] op_sel_hi:[1,1,1]
  v_pk_fma_f32 v[180:181], v[180:181], v[212:213], v[212:213] op_sel:[0,1,1] op_sel_hi:[1,1,1]
  v_pk_fma_f32 v[182:183], v[182:183], v[212:213], v[212:213] op_sel:[0,1,1] op_sel_hi:[1,1,1]
  v_rcp_f32 v176, v176
  v_rcp_f32 v177, v177
  v_rcp_f32 v178, v178
  v_rcp_f32 v179, v179
  v_rcp_f32 v180, v180
  v_rcp_f32 v181, v181
  v_rcp_f32 v182, v182
  v_rcp_f32 v183, v183
  v_pk_mul_f32 v[176:177], v[176:177], v[56:57]
  v_pk_mul_f32 v[178:179], v[178:179], v[58:59]
  v_pk_mul_f32 v[180:181], v[180:181], v[60:61]
  v_pk_mul_f32 v[182:183], v[182:183], v[62:63]
  v_cvt_pk_bf16_f32 v56, v176, v177
  v_cvt_pk_bf16_f32 v57, v178, v179
  v_cvt_pk_bf16_f32 v58, v180, v181
  v_cvt_pk_bf16_f32 v59, v182, v183
  buffer_store_dwordx4 v[48:51], v252, s[48:51], s62 offen offset:2048 sc1
  buffer_store_dwordx4 v[56:59], v252, s[48:51], s62 offen offset:3072 sc1
L_F_join:
  s_barrier
  ds_read_b64_tr_b16 v[64:65], v248 offset:0
  ds_read_b64_tr_b16 v[66:67], v248 offset:2048
  ds_read_b64_tr_b16 v[68:69], v249 offset:0
  ds_read_b64_tr_b16 v[70:71], v249 offset:2048
  ds_read_b64_tr_b16 v[72:73], v250 offset:0
  ds_read_b64_tr_b16 v[74:75], v250 offset:2048
  ds_read_b64_tr_b16 v[76:77], v251 offset:0
  ds_read_b64_tr_b16 v[78:79], v251 offset:2048
  v_add_u32 v244, s78, v248
  v_add_u32 v245, s78, v249
  v_add_u32 v246, s78, v250
  v_add_u32 v247, s78, v251
  s_add_u32 s78, s78, s69
  s_waitcnt vmcnt(4)
  s_cmp_eq_u32 s57, 3
  s_cbranch_scc1 L_F_nosig0
  s_mov_b32 s25, 1
  s_atomic_add s25, s[48:49], s74
L_F_nosig0:
  ds_read_b64_tr_b16 v[80:81], v248 offset:4096
  ds_read_b64_tr_b16 v[82:83], v248 offset:6144
  ds_read_b64_tr_b16 v[84:85], v249 offset:4096
  ds_read_b64_tr_b16 v[86:87], v249 offset:6144
  ds_read_b64_tr_b16 v[88:89], v250 offset:4096
  ds_read_b64_tr_b16 v[90:91], v250 offset:6144
  ds_read_b64_tr_b16 v[92:93], v251 offset:4096
  ds_read_b64_tr_b16 v[94:95], v251 offset:6144
  s_waitcnt lgkmcnt(8)
  s_add_u32 m0, s69, 0
  s_nop 0
  buffer_load_dwordx4 v232, s[32:35], s75 offen lds
  s_add_u32 m0, s69, 1024
  s_add_u32 s75, s75, 8192
  buffer_load_dwordx4 v232, s[32:35], s75 offen lds
  s_add_u32 m0, s69, 2048
  s_add_u32 s75, s75, 8192
  buffer_load_dwordx4 v232, s[32:35], s75 offen lds
  s_add_u32 m0, s69, 3072
  s_add_u32 s75, s75, 8192
  buffer_load_dwordx4 v232, s[32:35], s75 offen lds
  ds_read_b64_tr_b16 v[96:97], v248 offset:8192
  ds_read_b64_tr_b16 v[98:99], v248 offset:10240
  ds_read_b64_tr_b16 v[100:101], v249 offset:8192
  ds_read_b64_tr_b16 v[102:103], v249 offset:10240
  ds_read_b64_tr_b16 v[104:105], v250 offset:8192
  ds_read_b64_tr_b16 v[106:107], v250 offset:10240
  ds_read_b64_tr_b16 v[108:109], v251 offset:8192
  ds_read_b64_tr_b16 v[110:111], v251 offset:10240
  s_waitcnt lgkmcnt(8)
  s_add_u32 m0, s69, 4096
  s_add_u32 s75, s75, 40960
  buffer_load_dwordx4 v232, s[32:35], s75 offen lds
  s_add_u32 m0, s69, 5120
  s_add_u32 s75, s75, 8192
  buffer_load_dwordx4 v232, s[32:35], s75 offen lds
  s_add_u32 m0, s69, 6144
  s_add_u32 s75, s75, 8192
  buffer_load_dwordx4 v232, s[32:35], s75 offen lds
  s_add_u32 m0, s69, 7168
  s_add_u32 s75, s75, 8192
  buffer_load_dwordx4 v232, s[32:35], s75 offen lds
  ds_read_b64_tr_b16 v[112:113], v248 offset:12288
  ds_read_b64_tr_b16 v[114:115], v248 offset:14336
  ds_read_b64_tr_b16 v[116:117], v249 offset:12288
  ds_read_b64_tr_b16 v[118:119], v249 offset:14336
  ds_read_b64_tr_b16 v[120:121], v250 offset:12288
  ds_read_b64_tr_b16 v[122:123], v250 offset:14336
  ds_read_b64_tr_b16 v[124:125], v251 offset:12288
  ds_read_b64_tr_b16 v[126:127], v251 offset:14336
  s_waitcnt lgkmcnt(8)
  s_add_u32 m0, s69, 8192
  s_add_u32 s75, s75, 40960
  buffer_load_dwordx4 v232, s[32:35], s75 offen lds
  s_add_u32 m0, s69, 9216
  s_add_u32 s75, s75, 8192
  buffer_load_dwordx4 v232, s[32:35], s75 offen lds
  s_add_u32 m0, s69, 10240
  s_add_u32 s75, s75, 8192
  buffer_load_dwordx4 v232, s[32:35], s75 offen lds
  s_add_u32 m0, s69, 11264
  s_add_u32 s75, s75, 8192
  buffer_load_dwordx4 v232, s[32:35], s75 offen lds
  s_barrier
  ds_read_b64_tr_b16 v[128:129], v244 offset:0
  ds_read_b64_tr_b16 v[130:131], v244 offset:2048
  ds_read_b64_tr_b16 v[132:133], v245 offset:0
  ds_read_b64_tr_b16 v[134:135], v245 offset:2048
  ds_read_b64_tr_b16 v[136:137], v246 offset:0
  ds_read_b64_tr_b16 v[138:139], v246 offset:2048
  ds_read_b64_tr_b16 v[140:141], v247 offset:0
  ds_read_b64_tr_b16 v[142:143], v247 offset:2048
  s_waitcnt lgkmcnt(8)
  s_add_u32 m0, s69, 12288
  s_add_u32 s75, s75, 40960
  buffer_load_dwordx4 v232, s[32:35], s75 offen lds
  s_add_u32 m0, s69, 13312
  s_add_u32 s75, s75, 8192
  buffer_load_dwordx4 v232, s[32:35], s75 offen lds
  s_add_u32 m0, s69, 14336
  s_add_u32 s75, s75, 8192
  buffer_load_dwordx4 v232, s[32:35], s75 offen lds
  s_add_u32 m0, s69, 15360
  s_add_u32 s75, s75, 8192
  buffer_load_dwordx4 v232, s[32:35], s75 offen lds
  ds_read_b64_tr_b16 v[144:145], v244 offset:4096
  ds_read_b64_tr_b16 v[146:147], v244 offset:6144
  ds_read_b64_tr_b16 v[148:149], v245 offset:4096
  ds_read_b64_tr_b16 v[150:151], v245 offset:6144
  ds_read_b64_tr_b16 v[152:153], v246 offset:4096
  ds_read_b64_tr_b16 v[154:155], v246 offset:6144
  ds_read_b64_tr_b16 v[156:157], v247 offset:4096
  ds_read_b64_tr_b16 v[158:159], v247 offset:6144
  s_waitcnt lgkmcnt(8)
  s_load_dword s24, s[48:49], s68 glc
  s_add_u32 m0, s78, 0
  s_add_u32 s75, s75, 40960
  buffer_load_dwordx4 v232, s[32:35], s75 offen lds
  s_add_u32 m0, s78, 1024
  s_add_u32 s75, s75, 8192
  buffer_load_dwordx4 v232, s[32:35], s75 offen lds
  s_add_u32 m0, s78, 2048
  s_add_u32 s75, s75, 8192
  buffer_load_dwordx4 v232, s[32:35], s75 offen lds
  s_add_u32 m0, s78, 3072
  s_add_u32 s75, s75, 8192
  buffer_load_dwordx4 v232, s[32:35], s75 offen lds
  ds_read_b64_tr_b16 v[160:161], v244 offset:8192
  ds_read_b64_tr_b16 v[162:163], v244 offset:10240
  ds_read_b64_tr_b16 v[164:165], v245 offset:8192
  ds_read_b64_tr_b16 v[166:167], v245 offset:10240
  ds_read_b64_tr_b16 v[168:169], v246 offset:8192
  ds_read_b64_tr_b16 v[170:171], v246 offset:10240
  ds_read_b64_tr_b16 v[172:173], v247 offset:8192
  ds_read_b64_tr_b16 v[174:175], v247 offset:10240
  s_waitcnt lgkmcnt(8)
  s_add_u32 m0, s78, 4096
  s_add_u32 s75, s75, 40960
  buffer_load_dwordx4 v232, s[32:35], s75 offen lds
  s_add_u32 m0, s78, 5120
  s_add_u32 s75, s75, 8192
  buffer_load_dwordx4 v232, s[32:35], s75 offen lds
  s_add_u32 m0, s78, 6144
  s_add_u32 s75, s75, 8192
  buffer_load_dwordx4 v232, s[32:35], s75 offen lds
  s_add_u32 m0, s78, 7168
  s_add_u32 s75, s75, 8192
  buffer_load_dwordx4 v232, s[32:35], s75 offen lds
  s_mov_b32 s72, 0
L_pollH:
  s_waitcnt lgkmcnt(0)
  s_cmp_ge_u32 s24, 7
  s_cbranch_scc1 L_pollH_ok
L_pollH_re:
  s_add_u32 s72, s72, 1
  s_cmp_ge_u32 s72, 50000
  s_cbranch_scc1 L_pollH_ok
  s_sleep 2
  s_load_dword s24, s[48:49], s68 glc
  s_branch L_pollH
L_pollH_ok:
  s_waitcnt vmcnt(24)
  s_cmp_eq_u32 s57, 3
  s_cbranch_scc1 L_F_nosig1
  s_add_u32 s74, s74, 16
  s_mov_b32 s26, 1
  s_atomic_add s26, s[48:49], s74
L_F_nosig1:
  s_add_u32 m0, s78, 8192
  s_add_u32 s75, s75, 40960
  buffer_load_dwordx4 v232, s[32:35], s75 offen lds
  buffer_load_dwordx4 v[176:179], v252, s[48:51], s76 offen offset:0 sc1
  s_add_u32 m0, s78, 9216
  s_add_u32 s75, s75, 8192
  buffer_load_dwordx4 v232, s[32:35], s75 offen lds
  buffer_load_dwordx4 v[180:183], v252, s[48:51], s76 offen offset:1024 sc1
  s_add_u32 m0, s78, 10240
  s_add_u32 s75, s75, 8192
  buffer_load_dwordx4 v232, s[32:35], s75 offen lds
  buffer_load_dwordx4 v[184:187], v252, s[48:51], s76 offen offset:2048 sc1
  s_add_u32 m0, s78, 11264
  s_add_u32 s75, s75, 8192
  buffer_load_dwordx4 v232, s[32:35], s75 offen lds
  buffer_load_dwordx4 v[188:191], v252, s[48:51], s76 offen offset:3072 sc1
  s_add_u32 s76, s76, 8192
  buffer_load_dwordx4 v[192:195], v252, s[48:51], s76 offen offset:0 sc1
  buffer_load_dwordx4 v[196:199], v252, s[48:51], s76 offen offset:1024 sc1
  buffer_load_dwordx4 v[200:203], v252, s[48:51], s76 offen offset:2048 sc1
  buffer_load_dwordx4 v[204:207], v252, s[48:51], s76 offen offset:3072 sc1
  s_add_u32 s76, s76, 8192
  buffer_load_dwordx4 v[208:211], v252, s[48:51], s76 offen offset:0 sc1
  buffer_load_dwordx4 v[212:215], v252, s[48:51], s76 offen offset:1024 sc1
  buffer_load_dwordx4 v[216:219], v252, s[48:51], s76 offen offset:2048 sc1
  buffer_load_dwordx4 v[220:223], v252, s[48:51], s76 offen offset:3072 sc1
  s_add_u32 s76, s76, 8192
  buffer_load_dwordx4 v[224:227], v252, s[48:51], s76 offen offset:0 sc1
  buffer_load_dwordx4 v[228:231], v252, s[48:51], s76 offen offset:1024 sc1
  s_lshl2_add_u32 s62, s61, 160016
  v_mov_b32 v254, s62
  s_setprio 0
  s_waitcnt vmcnt(16)
  v_mfma_f32_16x16x32_bf16 v[0:3], v[176:179], v[64:67], 0
  v_mfma_f32_16x16x32_bf16 v[4:7], v[176:179], v[68:71], 0
  v_mfma_f32_16x16x32_bf16 v[8:11], v[176:179], v[72:75], 0
  v_mfma_f32_16x16x32_bf16 v[12:15], v[176:179], v[76:79], 0
  s_waitcnt vmcnt(14)
  v_mfma_f32_16x16x32_bf16 v[16:19], v[180:183], v[64:67], 0
L_warm_b0:
  s_cbranch_execz L_warm_ret
  s_nop 0
  buffer_load_dwordx4 v[176:179], v252, s[48:51], s76 offen offset:2048 sc1
  v_mfma_f32_16x16x32_bf16 v[20:23], v[180:183], v[68:71], 0
  v_mfma_f32_16x16x32_bf16 v[24:27], v[180:183], v[72:75], 0
  v_mfma_f32_16x16x32_bf16 v[28:31], v[180:183], v[76:79], 0
  s_waitcnt vmcnt(13)
  v_mfma_f32_16x16x32_bf16 v[32:35], v[184:187], v[64:67], 0
  buffer_load_dwordx4 v[180:183], v252, s[48:51], s76 offen offset:3072 sc1
  v_mfma_f32_16x16x32_bf16 v[36:39], v[184:187], v[68:71], 0
  v_mfma_f32_16x16x32_bf16 v[40:43], v[184:187], v[72:75], 0
  v_mfma_f32_16x16x32_bf16 v[44:47], v[184:187], v[76:79], 0
  s_waitcnt vmcnt(12)
  v_mfma_f32_16x16x32_bf16 v[48:51], v[188:191], v[64:67], 0
  s_add_u32 s76, s76, 8192
  buffer_load_dwordx4 v[184:187], v252, s[48:51], s76 offen offset:0 sc1
  v_mfma_f32_16x16x32_bf16 v[52:55], v[188:191], v[68:71], 0
  v_mfma_f32_16x16x32_bf16 v[56:59], v[188:191], v[72:75], 0
  v_mfma_f32_16x16x32_bf16 v[60:63], v[188:191], v[76:79], 0
  s_waitcnt vmcnt(12)
  v_mfma_f32_16x16x32_bf16 v[0:3], v[192:195], v[80:83], v[0:3]
  buffer_load_dwordx4 v[188:191], v252, s[48:51], s76 offen offset:1024 sc1
  v_mfma_f32_16x16x32_bf16 v[4:7], v[192:195], v[84:87], v[4:7]
  ds_read_b64_tr_b16 v[64:65], v248 offset:0
  v_mfma_f32_16x16x32_bf16 v[8:11], v[192:195], v[88:91], v[8:11]
  ds_read_b64_tr_b16 v[66:67], v248 offset:2048
  v_mfma_f32_16x16x32_bf16 v[12:15], v[192:195], v[92:95], v[12:15]
  s_waitcnt vmcnt(12)
  v_mfma_f32_16x16x32_bf16 v[16:19], v[196:199], v[80:83], v[16:19]
  buffer_load_dwordx4 v[192:195], v252, s[48:51], s76 offen offset:2048 sc1
  v_mfma_f32_16x16x32_bf16 v[20:23], v[196:199], v[84:87], v[20:23]
  ds_read_b64_tr_b16 v[68:69], v249 offset:0
  v_mfma_f32_16x16x32_bf16 v[24:27], v[196:199], v[88:91], v[24:27]
  ds_read_b64_tr_b16 v[70:71], v249 offset:2048
  v_mfma_f32_16x16x32_bf16 v[28:31], v[196:199], v[92:95], v[28:31]
  s_waitcnt vmcnt(12)
  v_mfma_f32_16x16x32_bf16 v[32:35], v[200:203], v[80:83], v[32:35]
  buffer_load_dwordx4 v[196:199], v252, s[48:51], s76 offen offset:3072 sc1
  v_mfma_f32_16x16x32_bf16 v[36:39], v[200:203], v[84:87], v[36:39]
  ds_read_b64_tr_b16 v[72:73], v250 offset:0
  v_mfma_f32_16x16x32_bf16 v[40:43], v[200:203], v[88:91], v[40:43]
  ds_read_b64_tr_b16 v[74:75], v250 offset:2048
  v_mfma_f32_16x16x32_bf16 v[44:47], v[200:203], v[92:95], v[44:47]
  s_waitcnt vmcnt(12)
  v_mfma_f32_16x16x32_bf16 v[48:51], v[204:207], v[80:83], v[48:51]
  s_add_u32 s76, s76, 8192
  buffer_load_dwordx4 v[200:203], v252, s[48:51], s76 offen offset:0 sc1
  v_mfma_f32_16x16x32_bf16 v[52:55], v[204:207], v[84:87], v[52:55]
  ds_read_b64_tr_b16 v[76:77], v251 offset:0
  v_mfma_f32_16x16x32_bf16 v[56:59], v[204:207], v[88:91], v[56:59]
  ds_read_b64_tr_b16 v[78:79], v251 offset:2048
  v_mfma_f32_16x16x32_bf16 v[60:63], v[204:207], v[92:95], v[60:63]
  s_waitcnt vmcnt(12)
  v_mfma_f32_16x16x32_bf16 v[0:3], v[208:211], v[96:99], v[0:3]
  buffer_load_dwordx4 v[204:207], v252, s[48:51], s76 offen offset:1024 sc1
  v_mfma_f32_16x16x32_bf16 v[4:7], v[208:211], v[100:103], v[4:7]
  ds_read_b64_tr_b16 v[80:81], v248 offset:4096
  v_mfma_f32_16x16x32_bf16 v[8:11], v[208:211], v[104:107], v[8:11]
  ds_read_b64_tr_b16 v[82:83], v248 offset:6144
  v_mfma_f32_16x16x32_bf16 v[12:15], v[208:211], v[108:111], v[12:15]
  s_waitcnt vmcnt(12)
  v_mfma_f32_16x16x32_bf16 v[16:19], v[212:215], v[96:99], v[16:19]
  buffer_load_dwordx4 v[208:211], v252, s[48:51], s76 offen offset:2048 sc1
  v_mfma_f32_16x16x32_bf16 v[20:23], v[212:215], v[100:103], v[20:23]
  ds_read_b64_tr_b16 v[84:85], v249 offset:4096
  v_mfma_f32_16x16x32_bf16 v[24:27], v[212:215], v[104:107], v[24:27]
  ds_read_b64_tr_b16 v[86:87], v249 offset:6144
  v_mfma_f32_16x16x32_bf16 v[28:31], v[212:215], v[108:111], v[28:31]
  s_waitcnt vmcnt(12)
  v_mfma_f32_16x16x32_bf16 v[32:35], v[216:219], v[96:99], v[32:35]
  buffer_load_dwordx4 v[212:215], v252, s[48:51], s76 offen offset:3072 sc1
  v_mfma_f32_16x16x32_bf16 v[36:39], v[216:219], v[100:103], v[36:39]
  ds_read_b64_tr_b16 v[88:89], v250 offset:4096
  v_mfma_f32_16x16x32_bf16 v[40:43], v[216:219], v[104:107], v[40:43]
  ds_read_b64_tr_b16 v[90:91], v250 offset:6144
  v_mfma_f32_16x16x32_bf16 v[44:47], v[216:219], v[108:111], v[44:47]
  s_waitcnt vmcnt(12)
  v_mfma_f32_16x16x32_bf16 v[48:51], v[220:223], v[96:99], v[48:51]
  s_add_u32 s76, s76, 8192
  buffer_load_dwordx4 v[216:219], v252, s[48:51], s76 offen offset:0 sc1
  v_mfma_f32_16x16x32_bf16 v[52:55], v[220:223], v[100:103], v[52:55]
  ds_read_b64_tr_b16 v[92:93], v251 offset:4096
  v_mfma_f32_16x16x32_bf16 v[56:59], v[220:223], v[104:107], v[56:59]
  ds_read_b64_tr_b16 v[94:95], v251 offset:6144
  v_mfma_f32_16x16x32_bf16 v[60:63], v[220:223], v[108:111], v[60:63]
  s_load_dword s24, s[48:49], s66 glc
  s_waitcnt vmcnt(12)
  v_mfma_f32_16x16x32_bf16 v[0:3], v[224:227], v[112:115], v[0:3]
  buffer_load_dwordx4 v[220:223], v252, s[48:51], s76 offen offset:1024 sc1
  v_mfma_f32_16x16x32_bf16 v[4:7], v[224:227], v[116:119], v[4:7]
  ds_read_b64_tr_b16 v[96:97], v248 offset:8192
  v_mfma_f32_16x16x32_bf16 v[8:11], v[224:227], v[120:123], v[8:11]
  ds_read_b64_tr_b16 v[98:99], v248 offset:10240
  v_mfma_f32_16x16x32_bf16 v[12:15], v[224:227], v[124:127], v[12:15]
  s_waitcnt vmcnt(12)
  v_mfma_f32_16x16x32_bf16 v[16:19], v[228:231], v[112:115], v[16:19]
  buffer_load_dwordx4 v[224:227], v252, s[48:51], s76 offen offset:2048 sc1
  v_mfma_f32_16x16x32_bf16 v[20:23], v[228:231], v[116:119], v[20:23]
  ds_read_b64_tr_b16 v[100:101], v249 offset:8192
  v_mfma_f32_16x16x32_bf16 v[24:27], v[228:231], v[120:123], v[24:27]
  ds_read_b64_tr_b16 v[102:103], v249 offset:10240
  v_mfma_f32_16x16x32_bf16 v[28:31], v[228:231], v[124:127], v[28:31]
  s_waitcnt vmcnt(12)
  v_mfma_f32_16x16x32_bf16 v[32:35], v[176:179], v[112:115], v[32:35]
  buffer_load_dwordx4 v[228:231], v252, s[48:51], s76 offen offset:3072 sc1
  v_mfma_f32_16x16x32_bf16 v[36:39], v[176:179], v[116:119], v[36:39]
  ds_read_b64_tr_b16 v[104:105], v250 offset:8192
  v_mfma_f32_16x16x32_bf16 v[40:43], v[176:179], v[120:123], v[40:43]
  ds_read_b64_tr_b16 v[106:107], v250 offset:10240
  v_mfma_f32_16x16x32_bf16 v[44:47], v[176:179], v[124:127], v[44:47]
  s_mov_b32 s72, 0
L_pollH2:
  s_waitcnt lgkmcnt(0)
  s_cmp_ge_u32 s24, 7
  s_cbranch_scc1 L_pollH2_ok
L_pollH2_re:
  s_add_u32 s72, s72, 1
  s_cmp_ge_u32 s72, 50000
  s_cbranch_scc1 L_pollH2_ok
  s_sleep 2
  s_load_dword s24, s[48:49], s66 glc
  s_branch L_pollH2
L_pollH2_ok:
  s_waitcnt vmcnt(12)
  v_mfma_f32_16x16x32_bf16 v[48:51], v[180:183], v[112:115], v[48:51]
  buffer_load_dwordx4 v[176:179], v252, s[48:51], s77 offen offset:0 sc1
  v_mfma_f32_16x16x32_bf16 v[52:55], v[180:183], v[116:119], v[52:55]
  ds_read_b64_tr_b16 v[108:109], v251 offset:8192
  v_mfma_f32_16x16x32_bf16 v[56:59], v[180:183], v[120:123], v[56:59]
  ds_read_b64_tr_b16 v[110:111], v251 offset:10240
  v_mfma_f32_16x16x32_bf16 v[60:63], v[180:183], v[124:127], v[60:63]
  s_waitcnt vmcnt(12)
  v_mfma_f32_16x16x32_bf16 v[0:3], v[184:187], v[128:131], v[0:3]
  buffer_load_dwordx4 v[180:183], v252, s[48:51], s77 offen offset:1024 sc1
  v_mfma_f32_16x16x32_bf16 v[4:7], v[184:187], v[132:135], v[4:7]
  ds_read_b64_tr_b16 v[112:113], v248 offset:12288
  v_mfma_f32_16x16x32_bf16 v[8:11], v[184:187], v[136:139], v[8:11]
  ds_read_b64_tr_b16 v[114:115], v248 offset:14336
  v_mfma_f32_16x16x32_bf16 v[12:15], v[184:187], v[140:143], v[12:15]
  s_waitcnt vmcnt(12)
  v_mfma_f32_16x16x32_bf16 v[16:19], v[188:191], v[128:131], v[16:19]
  buffer_load_dwordx4 v[184:187], v252, s[48:51], s77 offen offset:2048 sc1
  v_mfma_f32_16x16x32_bf16 v[20:23], v[188:191], v[132:135], v[20:23]
  ds_read_b64_tr_b16 v[116:117], v249 offset:12288
  v_mfma_f32_16x16x32_bf16 v[24:27], v[188:191], v[136:139], v[24:27]
  ds_read_b64_tr_b16 v[118:119], v249 offset:14336
  v_mfma_f32_16x16x32_bf16 v[28:31], v[188:191], v[140:143], v[28:31]
  s_waitcnt vmcnt(12)
  v_mfma_f32_16x16x32_bf16 v[32:35], v[192:195], v[128:131], v[32:35]
  buffer_load_dwordx4 v[188:191], v252, s[48:51], s77 offen offset:3072 sc1
  v_mfma_f32_16x16x32_bf16 v[36:39], v[192:195], v[132:135], v[36:39]
  ds_read_b64_tr_b16 v[120:121], v250 offset:12288
  v_mfma_f32_16x16x32_bf16 v[40:43], v[192:195], v[136:139], v[40:43]
  ds_read_b64_tr_b16 v[122:123], v250 offset:14336
  v_mfma_f32_16x16x32_bf16 v[44:47], v[192:195], v[140:143], v[44:47]
  s_waitcnt vmcnt(12)
  v_mfma_f32_16x16x32_bf16 v[48:51], v[196:199], v[128:131], v[48:51]
  s_add_u32 s77, s77, 8192
  buffer_load_dwordx4 v[192:195], v252, s[48:51], s77 offen offset:0 sc1
  v_mfma_f32_16x16x32_bf16 v[52:55], v[196:199], v[132:135], v[52:55]
  ds_read_b64_tr_b16 v[124:125], v251 offset:12288
  v_mfma_f32_16x16x32_bf16 v[56:59], v[196:199], v[136:139], v[56:59]
  ds_read_b64_tr_b16 v[126:127], v251 offset:14336
  v_mfma_f32_16x16x32_bf16 v[60:63], v[196:199], v[140:143], v[60:63]
  s_waitcnt vmcnt(12)
  v_mfma_f32_16x16x32_bf16 v[0:3], v[200:203], v[144:147], v[0:3]
  buffer_load_dwordx4 v[196:199], v252, s[48:51], s77 offen offset:1024 sc1
  v_mfma_f32_16x16x32_bf16 v[4:7], v[200:203], v[148:151], v[4:7]
  ds_read_b64_tr_b16 v[128:129], v244 offset:0
  v_mfma_f32_16x16x32_bf16 v[8:11], v[200:203], v[152:155], v[8:11]
  ds_read_b64_tr_b16 v[130:131], v244 offset:2048
  v_mfma_f32_16x16x32_bf16 v[12:15], v[200:203], v[156:159], v[12:15]
  s_waitcnt vmcnt(12)
  v_mfma_f32_16x16x32_bf16 v[16:19], v[204:207], v[144:147], v[16:19]
  buffer_load_dwordx4 v[200:203], v252, s[48:51], s77 offen offset:2048 sc1
  v_mfma_f32_16x16x32_bf16 v[20:23], v[204:207], v[148:151], v[20:23]
  ds_read_b64_tr_b16 v[132:133], v245 offset:0
  v_mfma_f32_16x16x32_bf16 v[24:27], v[204:207], v[152:155], v[24:27]
  ds_read_b64_tr_b16 v[134:135], v245 offset:2048
  v_mfma_f32_16x16x32_bf16 v[28:31], v[204:207], v[156:159], v[28:31]
  s_waitcnt vmcnt(12)
  v_mfma_f32_16x16x32_bf16 v[32:35], v[208:211], v[144:147], v[32:35]
  buffer_load_dwordx4 v[204:207], v252, s[48:51], s77 offen offset:3072 sc1
  v_mfma_f32_16x16x32_bf16 v[36:39], v[208:211], v[148:151], v[36:39]
  ds_read_b64_tr_b16 v[136:137], v246 offset:0
  v_mfma_f32_16x16x32_bf16 v[40:43], v[208:211], v[152:155], v[40:43]
  ds_read_b64_tr_b16 v[138:139], v246 offset:2048
  v_mfma_f32_16x16x32_bf16 v[44:47], v[208:211], v[156:159], v[44:47]
  s_waitcnt vmcnt(12)
  v_mfma_f32_16x16x32_bf16 v[48:51], v[212:215], v[144:147], v[48:51]
  s_add_u32 s77, s77, 8192
  buffer_load_dwordx4 v[208:211], v252, s[48:51], s77 offen offset:0 sc1
  v_mfma_f32_16x16x32_bf16 v[52:55], v[212:215], v[148:151], v[52:55]
  ds_read_b64_tr_b16 v[140:141], v247 offset:0
  v_mfma_f32_16x16x32_bf16 v[56:59], v[212:215], v[152:155], v[56:59]
  ds_read_b64_tr_b16 v[142:143], v247 offset:2048
  v_mfma_f32_16x16x32_bf16 v[60:63], v[212:215], v[156:159], v[60:63]
  s_waitcnt vmcnt(12)
  v_mfma_f32_16x16x32_bf16 v[0:3], v[216:219], v[160:163], v[0:3]
  buffer_load_dwordx4 v[212:215], v252, s[48:51], s77 offen offset:1024 sc1
  v_mfma_f32_16x16x32_bf16 v[4:7], v[216:219], v[164:167], v[4:7]
  ds_read_b64_tr_b16 v[144:145], v244 offset:4096
  v_mfma_f32_16x16x32_bf16 v[8:11], v[216:219], v[168:171], v[8:11]
  ds_read_b64_tr_b16 v[146:147], v244 offset:6144
  v_mfma_f32_16x16x32_bf16 v[12:15], v[216:219], v[172:175], v[12:15]
  s_waitcnt vmcnt(12)
  v_mfma_f32_16x16x32_bf16 v[16:19], v[220:223], v[160:163], v[16:19]
  s_add_u32 s8, s77, 8192
  buffer_load_dwordx4 v[216:219], v252, s[48:51], s8 offen offset:0 sc1
  v_mfma_f32_16x16x32_bf16 v[20:23], v[220:223], v[164:167], v[20:23]
  ds_read_b64_tr_b16 v[148:149], v245 offset:4096
  v_mfma_f32_16x16x32_bf16 v[24:27], v[220:223], v[168:171], v[24:27]
  ds_read_b64_tr_b16 v[150:151], v245 offset:6144
  v_mfma_f32_16x16x32_bf16 v[28:31], v[220:223], v[172:175], v[28:31]
  s_waitcnt vmcnt(12)
  v_mfma_f32_16x16x32_bf16 v[32:35], v[224:227], v[160:163], v[32:35]
  buffer_load_dwordx4 v[220:223], v252, s[48:51], s8 offen offset:1024 sc1
  v_mfma_f32_16x16x32_bf16 v[36:39], v[224:227], v[164:167], v[36:39]
  ds_read_b64_tr_b16 v[152:153], v246 offset:4096
  v_mfma_f32_16x16x32_bf16 v[40:43], v[224:227], v[168:171], v[40:43]
  ds_read_b64_tr_b16 v[154:155], v246 offset:6144
  v_mfma_f32_16x16x32_bf16 v[44:47], v[224:227], v[172:175], v[44:47]
  s_waitcnt vmcnt(12)
  v_mfma_f32_16x16x32_bf16 v[48:51], v[228:231], v[160:163], v[48:51]
  s_add_u32 s9, s8, 8192
  buffer_load_dwordx4 v[224:227], v252, s[48:51], s9 offen offset:0 sc1
  v_mfma_f32_16x16x32_bf16 v[52:55], v[228:231], v[164:167], v[52:55]
  ds_read_b64_tr_b16 v[156:157], v247 offset:4096
  v_mfma_f32_16x16x32_bf16 v[56:59], v[228:231], v[168:171], v[56:59]
  ds_read_b64_tr_b16 v[158:159], v247 offset:6144
  v_mfma_f32_16x16x32_bf16 v[60:63], v[228:231], v[172:175], v[60:63]
  s_waitcnt vmcnt(12)
  v_mfma_f32_16x16x32_bf16 v[0:3], v[176:179], v[64:67], v[0:3]
  buffer_load_dwordx4 v[228:231], v252, s[48:51], s9 offen offset:1024 sc1
  v_mfma_f32_16x16x32_bf16 v[4:7], v[176:179], v[68:71], v[4:7]
  ds_read_b64_tr_b16 v[160:161], v244 offset:8192
  v_mfma_f32_16x16x32_bf16 v[8:11], v[176:179], v[72:75], v[8:11]
  ds_read_b64_tr_b16 v[162:163], v244 offset:10240
  v_mfma_f32_16x16x32_bf16 v[12:15], v[176:179], v[76:79], v[12:15]
  s_waitcnt vmcnt(12)
  v_mfma_f32_16x16x32_bf16 v[16:19], v[180:183], v[64:67], v[16:19]
  s_add_u32 s10, s9, 8192
  buffer_load_dwordx4 v[176:179], v252, s[48:51], s10 offen offset:0 sc1
  v_mfma_f32_16x16x32_bf16 v[20:23], v[180:183], v[68:71], v[20:23]
  ds_read_b64_tr_b16 v[164:165], v245 offset:8192
  v_mfma_f32_16x16x32_bf16 v[24:27], v[180:183], v[72:75], v[24:27]
  ds_read_b64_tr_b16 v[166:167], v245 offset:10240
  v_mfma_f32_16x16x32_bf16 v[28:31], v[180:183], v[76:79], v[28:31]
  s_waitcnt vmcnt(12)
  v_mfma_f32_16x16x32_bf16 v[32:35], v[184:187], v[64:67], v[32:35]
  buffer_load_dwordx4 v[180:183], v252, s[48:51], s10 offen offset:1024 sc1
  v_mfma_f32_16x16x32_bf16 v[36:39], v[184:187], v[68:71], v[36:39]
  ds_read_b64_tr_b16 v[168:169], v246 offset:8192
  v_mfma_f32_16x16x32_bf16 v[40:43], v[184:187], v[72:75], v[40:43]
  ds_read_b64_tr_b16 v[170:171], v246 offset:10240
  v_mfma_f32_16x16x32_bf16 v[44:47], v[184:187], v[76:79], v[44:47]
  s_waitcnt vmcnt(12)
  v_mfma_f32_16x16x32_bf16 v[48:51], v[188:191], v[64:67], v[48:51]
  s_add_u32 s11, s10, 8192
  buffer_load_dwordx4 v[184:187], v252, s[48:51], s11 offen offset:0 sc1
  v_mfma_f32_16x16x32_bf16 v[52:55], v[188:191], v[68:71], v[52:55]
  ds_read_b64_tr_b16 v[172:173], v247 offset:8192
  v_mfma_f32_16x16x32_bf16 v[56:59], v[188:191], v[72:75], v[56:59]
  ds_read_b64_tr_b16 v[174:175], v247 offset:10240
  v_mfma_f32_16x16x32_bf16 v[60:63], v[188:191], v[76:79], v[60:63]
  s_waitcnt lgkmcnt(0)
  s_mov_b32 m0, s69
  s_waitcnt vmcnt(12)
  v_mfma_f32_16x16x32_bf16 v[0:3], v[192:195], v[80:83], v[0:3]
  buffer_load_dwordx4 v[188:191], v252, s[48:51], s11 offen offset:1024 sc1
  v_mfma_f32_16x16x32_bf16 v[4:7], v[192:195], v[84:87], v[4:7]
  v_mfma_f32_16x16x32_bf16 v[8:11], v[192:195], v[88:91], v[8:11]
  v_mfma_f32_16x16x32_bf16 v[12:15], v[192:195], v[92:95], v[12:15]
  s_waitcnt vmcnt(12)
  v_mfma_f32_16x16x32_bf16 v[16:19], v[196:199], v[80:83], v[16:19]
  buffer_load_dwordx4 v[192:195], v252, s[48:51], s77 offen offset:2048 sc1
  v_mfma_f32_16x16x32_bf16 v[20:23], v[196:199], v[84:87], v[20:23]
  v_mfma_f32_16x16x32_bf16 v[24:27], v[196:199], v[88:91], v[24:27]
  v_mfma_f32_16x16x32_bf16 v[28:31], v[196:199], v[92:95], v[28:31]
  s_waitcnt vmcnt(12)
  v_mfma_f32_16x16x32_bf16 v[32:35], v[200:203], v[80:83], v[32:35]
  buffer_load_dwordx4 v[196:199], v252, s[48:51], s77 offen offset:3072 sc1
  v_mfma_f32_16x16x32_bf16 v[36:39], v[200:203], v[84:87], v[36:39]
  v_mfma_f32_16x16x32_bf16 v[40:43], v[200:203], v[88:91], v[40:43]
  v_mfma_f32_16x16x32_bf16 v[44:47], v[200:203], v[92:95], v[44:47]
  s_waitcnt vmcnt(12)
  v_mfma_f32_16x16x32_bf16 v[48:51], v[204:207], v[80:83], v[48:51]
  buffer_load_dwordx4 v[200:203], v252, s[48:51], s8 offen offset:2048 sc1
  v_mfma_f32_16x16x32_bf16 v[52:55], v[204:207], v[84:87], v[52:55]
  v_mfma_f32_16x16x32_bf16 v[56:59], v[204:207], v[88:91], v[56:59]
  v_mfma_f32_16x16x32_bf16 v[60:63], v[204:207], v[92:95], v[60:63]
  s_waitcnt vmcnt(12)
  v_mfma_f32_16x16x32_bf16 v[0:3], v[208:211], v[96:99], v[0:3]
  buffer_load_dwordx4 v[204:207], v252, s[48:51], s8 offen offset:3072 sc1
  v_mfma_f32_16x16x32_bf16 v[4:7], v[208:211], v[100:103], v[4:7]
  v_mfma_f32_16x16x32_bf16 v[8:11], v[208:211], v[104:107], v[8:11]
  v_mfma_f32_16x16x32_bf16 v[12:15], v[208:211], v[108:111], v[12:15]
  s_waitcnt vmcnt(12)
  v_mfma_f32_16x16x32_bf16 v[16:19], v[212:215], v[96:99], v[16:19]
  buffer_load_dwordx4 v[208:211], v252, s[48:51], s9 offen offset:2048 sc1
  v_mfma_f32_16x16x32_bf16 v[20:23], v[212:215], v[100:103], v[20:23]
  v_mfma_f32_16x16x32_bf16 v[24:27], v[212:215], v[104:107], v[24:27]
  v_mfma_f32_16x16x32_bf16 v[28:31], v[212:215], v[108:111], v[28:31]
  s_waitcnt vmcnt(12)
  v_mfma_f32_16x16x32_bf16 v[0:3], v[216:219], v[112:115], v[0:3]
  buffer_load_dwordx4 v[212:215], v252, s[48:51], s9 offen offset:3072 sc1
  v_mfma_f32_16x16x32_bf16 v[4:7], v[216:219], v[116:119], v[4:7]
  v_mfma_f32_16x16x32_bf16 v[8:11], v[216:219], v[120:123], v[8:11]
  v_mfma_f32_16x16x32_bf16 v[12:15], v[216:219], v[124:127], v[12:15]
  s_waitcnt vmcnt(12)
  v_mfma_f32_16x16x32_bf16 v[16:19], v[220:223], v[112:115], v[16:19]
  buffer_load_dwordx4 v[216:219], v252, s[48:51], s10 offen offset:2048 sc1
  v_mfma_f32_16x16x32_bf16 v[20:23], v[220:223], v[116:119], v[20:23]
  v_mfma_f32_16x16x32_bf16 v[24:27], v[220:223], v[120:123], v[24:27]
  v_mfma_f32_16x16x32_bf16 v[28:31], v[220:223], v[124:127], v[28:31]
  s_waitcnt vmcnt(12)
  v_mfma_f32_16x16x32_bf16 v[0:3], v[224:227], v[128:131], v[0:3]
  buffer_load_dwordx4 v[220:223], v252, s[48:51], s11 offen offset:2048 sc1
  v_mfma_f32_16x16x32_bf16 v[4:7], v[224:227], v[132:135], v[4:7]
  v_mfma_f32_16x16x32_bf16 v[8:11], v[224:227], v[136:139], v[8:11]
  v_mfma_f32_16x16x32_bf16 v[12:15], v[224:227], v[140:143], v[12:15]
  s_waitcnt vmcnt(12)
  v_mfma_f32_16x16x32_bf16 v[16:19], v[228:231], v[128:131], v[16:19]
  buffer_load_dwordx4 v[224:227], v252, s[48:51], s10 offen offset:3072 sc1
  v_mfma_f32_16x16x32_bf16 v[20:23], v[228:231], v[132:135], v[20:23]
  v_mfma_f32_16x16x32_bf16 v[24:27], v[228:231], v[136:139], v[24:27]
  v_mfma_f32_16x16x32_bf16 v[28:31], v[228:231], v[140:143], v[28:31]
  s_waitcnt vmcnt(12)
  v_mfma_f32_16x16x32_bf16 v[0:3], v[176:179], v[144:147], v[0:3]
  buffer_load_dwordx4 v[228:231], v252, s[48:51], s11 offen offset:3072 sc1
  v_mfma_f32_16x16x32_bf16 v[4:7], v[176:179], v[148:151], v[4:7]
  v_mfma_f32_16x16x32_bf16 v[8:11], v[176:179], v[152:155], v[8:11]
  v_mfma_f32_16x16x32_bf16 v[12:15], v[176:179], v[156:159], v[12:15]
  s_waitcnt vmcnt(12)
  v_mfma_f32_16x16x32_bf16 v[16:19], v[180:183], v[144:147], v[16:19]
  v_mfma_f32_16x16x32_bf16 v[20:23], v[180:183], v[148:151], v[20:23]
  v_mfma_f32_16x16x32_bf16 v[24:27], v[180:183], v[152:155], v[24:27]
  v_mfma_f32_16x16x32_bf16 v[28:31], v[180:183], v[156:159], v[28:31]
  ds_write_b32 v254, v253
  s_waitcnt vmcnt(11)
  v_mfma_f32_16x16x32_bf16 v[0:3], v[184:187], v[160:163], v[0:3]
  v_mfma_f32_16x16x32_bf16 v[4:7], v[184:187], v[164:167], v[4:7]
  v_mfma_f32_16x16x32_bf16 v[8:11], v[184:187], v[168:171], v[8:11]
  v_mfma_f32_16x16x32_bf16 v[12:15], v[184:187], v[172:175], v[12:15]
  s_waitcnt vmcnt(10)
  v_mfma_f32_16x16x32_bf16 v[16:19], v[188:191], v[160:163], v[16:19]
  v_mfma_f32_16x16x32_bf16 v[20:23], v[188:191], v[164:167], v[20:23]
  v_mfma_f32_16x16x32_bf16 v[24:27], v[188:191], v[168:171], v[24:27]
  v_mfma_f32_16x16x32_bf16 v[28:31], v[188:191], v[172:175], v[28:31]
  s_waitcnt vmcnt(9)
  v_mfma_f32_16x16x32_bf16 v[32:35], v[192:195], v[96:99], v[32:35]
  v_mfma_f32_16x16x32_bf16 v[36:39], v[192:195], v[100:103], v[36:39]
  ds_write_addtid_b32 v0 offset:0
  ds_write_addtid_b32 v1 offset:272
  v_mfma_f32_16x16x32_bf16 v[40:43], v[192:195], v[104:107], v[40:43]
  ds_write_addtid_b32 v2 offset:544
  ds_write_addtid_b32 v3 offset:816
  v_mfma_f32_16x16x32_bf16 v[44:47], v[192:195], v[108:111], v[44:47]
  ds_write_addtid_b32 v4 offset:1152
  ds_write_addtid_b32 v5 offset:1424
  s_waitcnt vmcnt(8)
  v_mfma_f32_16x16x32_bf16 v[48:51], v[196:199], v[96:99], v[48:51]
  ds_write_addtid_b32 v6 offset:1696
  ds_write_addtid_b32 v7 offset:1968
  v_mfma_f32_16x16x32_bf16 v[52:55], v[196:199], v[100:103], v[52:55]
  ds_write_addtid_b32 v8 offset:2304
  ds_write_addtid_b32 v9 offset:2576
  v_mfma_f32_16x16x32_bf16 v[56:59], v[196:199], v[104:107], v[56:59]
  ds_write_addtid_b32 v10 offset:2848
  ds_write_addtid_b32 v11 offset:3120
  v_mfma_f32_16x16x32_bf16 v[60:63], v[196:199], v[108:111], v[60:63]
  ds_write_addtid_b32 v12 offset:3456
  ds_write_addtid_b32 v13 offset:3728
  s_waitcnt vmcnt(7)
  v_mfma_f32_16x16x32_bf16 v[32:35], v[200:203], v[112:115], v[32:35]
  ds_write_addtid_b32 v14 offset:4000
  ds_write_addtid_b32 v15 offset:4272
  v_mfma_f32_16x16x32_bf16 v[36:39], v[200:203], v[116:119], v[36:39]
  ds_write_addtid_b32 v16 offset:4608
  ds_write_addtid_b32 v17 offset:4880
  v_mfma_f32_16x16x32_bf16 v[40:43], v[200:203], v[120:123], v[40:43]
  ds_write_addtid_b32 v18 offset:5152
  ds_write_addtid_b32 v19 offset:5424
  v_mfma_f32_16x16x32_bf16 v[44:47], v[200:203], v[124:127], v[44:47]
  ds_write_addtid_b32 v20 offset:5760
  ds_write_addtid_b32 v21 offset:6032
  s_waitcnt vmcnt(6)
  v_mfma_f32_16x16x32_bf16 v[48:51], v[204:207], v[112:115], v[48:51]
  ds_write_addtid_b32 v22 offset:6304
  ds_write_addtid_b32 v23 offset:6576
  v_mfma_f32_16x16x32_bf16 v[52:55], v[204:207], v[116:119], v[52:55]
  ds_write_addtid_b32 v24 offset:6912
  ds_write_addtid_b32 v25 offset:7184
  v_mfma_f32_16x16x32_bf16 v[56:59], v[204:207], v[120:123], v[56:59]
  ds_write_addtid_b32 v26 offset:7456
  ds_write_addtid_b32 v27 offset:7728
  v_mfma_f32_16x16x32_bf16 v[60:63], v[204:207], v[124:127], v[60:63]
  ds_write_addtid_b32 v28 offset:8064
  ds_write_addtid_b32 v29 offset:8336
  s_waitcnt vmcnt(5)
  v_mfma_f32_16x16x32_bf16 v[32:35], v[208:211], v[128:131], v[32:35]
  ds_write_addtid_b32 v30 offset:8608
  ds_write_addtid_b32 v31 offset:8880
  v_mfma_f32_16x16x32_bf16 v[36:39], v[208:211], v[132:135], v[36:39]
  v_mfma_f32_16x16x32_bf16 v[40:43], v[208:211], v[136:139], v[40:43]
  v_mfma_f32_16x16x32_bf16 v[44:47], v[208:211], v[140:143], v[44:47]
  s_waitcnt lgkmcnt(0)
  s_barrier
  s_sub_u32 m0, s78, 49152
  s_waitcnt vmcnt(4)
  v_mfma_f32_16x16x32_bf16 v[48:51], v[212:215], v[128:131], v[48:51]
  v_mfma_f32_16x16x32_bf16 v[52:55], v[212:215], v[132:135], v[52:55]
  v_mfma_f32_16x16x32_bf16 v[56:59], v[212:215], v[136:139], v[56:59]
  v_mfma_f32_16x16x32_bf16 v[60:63], v[212:215], v[140:143], v[60:63]
  s_waitcnt vmcnt(3)
  v_mfma_f32_16x16x32_bf16 v[32:35], v[216:219], v[144:147], v[32:35]
  v_mfma_f32_16x16x32_bf16 v[36:39], v[216:219], v[148:151], v[36:39]
  v_mfma_f32_16x16x32_bf16 v[40:43], v[216:219], v[152:155], v[40:43]
  v_mfma_f32_16x16x32_bf16 v[44:47], v[216:219], v[156:159], v[44:47]
  s_waitcnt vmcnt(2)
  v_mfma_f32_16x16x32_bf16 v[32:35], v[220:223], v[160:163], v[32:35]
  v_mfma_f32_16x16x32_bf16 v[36:39], v[220:223], v[164:167], v[36:39]
  v_mfma_f32_16x16x32_bf16 v[40:43], v[220:223], v[168:171], v[40:43]
  v_mfma_f32_16x16x32_bf16 v[44:47], v[220:223], v[172:175], v[44:47]
  s_waitcnt vmcnt(1)
  v_mfma_f32_16x16x32_bf16 v[48:51], v[224:227], v[144:147], v[48:51]
  v_mfma_f32_16x16x32_bf16 v[52:55], v[224:227], v[148:151], v[52:55]
  v_mfma_f32_16x16x32_bf16 v[56:59], v[224:227], v[152:155], v[56:59]
  s_nop 0
  ds_write_addtid_b32 v32 offset:49152
  ds_write_addtid_b32 v33 offset:49424
  v_mfma_f32_16x16x32_bf16 v[60:63], v[224:227], v[156:159], v[60:63]
  ds_write_addtid_b32 v34 offset:49696
  ds_write_addtid_b32 v35 offset:49968
  s_waitcnt vmcnt(0)
  v_mfma_f32_16x16x32_bf16 v[48:51], v[228:231], v[160:163], v[48:51]
  ds_write_addtid_b32 v36 offset:50304
  ds_write_addtid_b32 v37 offset:50576
  v_mfma_f32_16x16x32_bf16 v[52:55], v[228:231], v[164:167], v[52:55]
  ds_write_addtid_b32 v38 offset:50848
  ds_write_addtid_b32 v39 offset:51120
  v_mfma_f32_16x16x32_bf16 v[56:59], v[228:231], v[168:171], v[56:59]
  ds_write_addtid_b32 v40 offset:51456
  ds_write_addtid_b32 v41 offset:51728
  v_mfma_f32_16x16x32_bf16 v[60:63], v[228:231], v[172:175], v[60:63]
  ds_write_addtid_b32 v42 offset:52000
  ds_write_addtid_b32 v43 offset:52272
  ds_write_addtid_b32 v44 offset:52608
  ds_write_addtid_b32 v45 offset:52880
  ds_write_addtid_b32 v46 offset:53152
  ds_write_addtid_b32 v47 offset:53424
  ds_write_addtid_b32 v48 offset:53760
  ds_write_addtid_b32 v49 offset:54032
  ds_write_addtid_b32 v50 offset:54304
  ds_write_addtid_b32 v51 offset:54576
  ds_write_addtid_b32 v52 offset:54912
  ds_write_addtid_b32 v53 offset:55184
  ds_write_addtid_b32 v54 offset:55456
  ds_write_addtid_b32 v55 offset:55728
  ds_write_addtid_b32 v56 offset:56064
  ds_write_addtid_b32 v57 offset:56336
  ds_write_addtid_b32 v58 offset:56608
  ds_write_addtid_b32 v59 offset:56880
  ds_write_addtid_b32 v60 offset:57216
  ds_write_addtid_b32 v61 offset:57488
  ds_write_addtid_b32 v62 offset:57760
  ds_write_addtid_b32 v63 offset:58032
  s_waitcnt lgkmcnt(0)
  s_barrier
  s_endpgm

L_C2:
  s_bitcmp1_b32 s18, 0
  s_mov_b32 s63, 0x76543210
  s_cselect_b32 s63, 0x75634021, s63
  s_mul_i32 s19, s19, 0x11111111
  s_add_u32 s66, s63, s19
  s_load_dwordx2 s[44:45], s[0:1], 96
  s_load_dwordx2 s[20:21], s[0:1], 32
  s_load_dwordx2 s[32:33], s[0:1], 72
  s_load_dwordx2 s[36:37], s[0:1], 80
  s_load_dwordx2 s[40:41], s[0:1], 88
  s_load_dwordx2 s[52:53], s[0:1], 40
  s_mov_b32 s50, 16777216
  s_mov_b32 s51, 0x20000
  s_mov_b32 s46, 256
  s_mov_b32 s47, 0x20000
  s_mov_b32 s22, 2097152
  s_mov_b32 s23, 0x20000
  s_mov_b32 s38, 1024
  s_mov_b32 s39, 0x20000
  s_bfe_u32 s79, s55, 0x10002
  s_lshl1_add_u32 s79, s58, s79
  s_lshr_b32 s31, s55, 3
  s_xor_b32 s31, s31, 3
  s_and_b32 s3, s2, 1
  s_lshl2_add_u32 s31, s3, s31
  s_lshr_b32 s3, s54, 1
  s_lshl1_add_u32 s3, s55, s3
  v_lshrrev_b32 v1, 5, v255
  s_lshr_b32 s63, s55, 3
  s_lshl2_add_u32 s63, s54, s63
  s_lshr_b32 s64, s61, 1
  s_lshl1_add_u32 s63, s63, s64
  s_and_b32 s64, s55, 7
  s_lshl3_add_u32 s60, s63, s64
  s_lshr_b32 s63, s56, 1
  s_add_u32 s63, s63, 8
  s_lshl_b32 s8, s63, 7
  s_lshl_b32 s16, s57, 7
  v_bfe_u32 v6, v255, 2, 1
  v_bfe_u32 v7, v255, 3, 1
  v_and_b32 v16, 1, v5
  v_xor_b32 v16, v16, v6
  v_xor_b32 v16, v16, v7
  v_lshl_add_u32 v6, v16, 1, v6
  v_lshl_add_u32 v17, v7, 2, v6
  s_and_b32 s63, s61, 1
  s_lshl_b32 s63, s63, 3
  v_lshl_add_u32 v247, v1, 4, v17
  v_add_u32 v247, s63, v247
  s_and_b32 s63, s60, -2
  s_lshl_b32 s63, s63, 1
  s_waitcnt lgkmcnt(0)
  s_load_dword s68, s[52:53], s63
  s_lshr_b32 s64, s61, 1
  s_lshl1_add_u32 s63, s31, s64
  s_lshl_b32 s63, s63, 6
  s_lshl_b32 s30, s79, 16
  s_add_u32 s30, s30, s63
  v_and_b32 v186, 48, v252
  buffer_load_dwordx4 v[228:231], v186, s[36:39], s63 offen
  s_and_b32 s63, s79, 1
  s_lshl_b32 s63, s63, 6
  v_add_u32 v20, s63, v247
  v_bfe_u32 v21, v20, 1, 3
  v_and_b32 v22, 3, v255
  v_lshl_add_u32 v22, s64, 2, v22
  v_xor_b32 v21, v21, v22
  v_lshlrev_b32 v21, 4, v21
  v_lshl_add_u32 v244, v20, 7, v21
  v_add_u32 v245, 0x10000, v244
  v_mov_b32 v21, 156928
  v_lshl_add_u32 v187, v20, 4, v21
  s_lshr_b32 s28, s61, 1
  s_and_b32 s15, s61, 1
  s_lshl3_add_u32 s28, s28, s15
  s_lshl_b32 s28, s28, 12
  s_add_u32 s28, s28, 90112
  s_xor_b32 s29, s28, 4096
  s_mov_b32 s34, 1835008
  s_mov_b32 s35, 0x20000
  s_add_u32 s78, s58, 8
  s_lshl_b32 s9, s78, 7
  s_add_u32 s78, s59, 24
  s_lshl_b32 s10, s78, 7
  s_lshl_b32 s11, s54, 7
  s_lshl_b32 s18, s31, 7
  v_lshlrev_b32 v6, 1, v5
  v_xor_b32 v6, v6, v4
  v_lshlrev_b32 v6, 4, v6
  v_lshl_add_u32 v6, v3, 10, v6
  s_lshl_b32 s15, s61, 13
  s_lshl_b32 s78, s31, 7
  s_add_u32 m0, s69, 20480
  s_add_u32 s15, s15, s78
  v_add_u32 v240, s15, v6
  s_add_u32 s15, s3, 0
  s_and_b32 s15, s15, 3
  s_mul_i32 s73, s15, 458752
  s_add_u32 s15, s3, 1
  s_and_b32 s15, s15, 3
  s_mul_i32 s74, s15, 458752
  s_add_u32 s15, s3, 2
  s_and_b32 s15, s15, 3
  buffer_load_dwordx4 v237, s[24:27], s71 offen lds
  s_add_u32 m0, s69, 4096
  s_mul_i32 s75, s15, 458752
  s_add_u32 s15, s3, 3
  s_and_b32 s15, s15, 3
  s_mul_i32 s76, s15, 458752
  v_xor_b32 v6, v5, v4
  v_lshlrev_b32 v6, 4, v6
  v_lshl_add_u32 v243, v3, 7, v6
  v_xor_b32 v242, 64, v243
  v_bfe_u32 v6, v255, 2, 2
  v_and_b32 v7, 3, v255
  buffer_load_dwordx4 v233, s[4:7], s70 offen lds
L_warm_c0:
  s_cbranch_execz L_warm_ret
  s_nop 0
  s_add_u32 m0, s69, 24576
  v_sub_u32 v6, v7, v6
  v_lshlrev_b32 v6, 3, v6
  v_lshlrev_b32 v7, 6, v5
  v_sub_u32 v6, v6, v7
  s_and_b32 s15, s61, 2
  s_mul_i32 s78, s15, 4144
  s_add_u32 s78, s78, 131296
  v_add_u32 v200, s78, v6
  v_add_u32 v201, 4144, v200
  v_and_b32 v6, 15, v255
  buffer_load_dwordx4 v238, s[24:27], s71 offen lds
  s_add_u32 m0, s69, 8192
  v_lshl_add_u32 v7, v5, 1, v6
  s_lshl_b32 s15, s15, 1
  s_and_b32 s78, s61, 1
  s_add_u32 s78, s78, s15
  v_add_u32 v16, 1, v7
  v_and_b32 v18, 1, v16
  v_lshlrev_b32 v18, 3, v18
  v_lshrrev_b32 v19, 1, v16
  v_lshl_add_u32 v18, v19, 7, v18
  v_add_u32 v18, 147712, v18
  buffer_load_dwordx4 v234, s[4:7], s70 offen lds
  s_add_u32 m0, s69, 28672
  v_lshrrev_b32 v16, 2, v16
  v_and_b32 v17, 7, v16
  v_xor_b32 v17, s78, v17
  v_lshl_add_u32 v202, v17, 4, v18
  v_xor_b32 v206, 64, v202
  v_add_u32 v16, 2, v16
  v_and_b32 v17, 7, v16
  v_xor_b32 v17, s78, v17
  v_lshl_add_u32 v204, v17, 4, v18
  v_xor_b32 v208, 64, v204
  buffer_load_dwordx4 v239, s[24:27], s71 offen lds
  s_add_u32 m0, s69, 12288
  v_add_u32 v16, 2, v7
  v_and_b32 v18, 1, v16
  v_lshlrev_b32 v18, 3, v18
  v_lshrrev_b32 v19, 1, v16
  v_lshl_add_u32 v18, v19, 7, v18
  v_add_u32 v18, 147712, v18
  v_lshrrev_b32 v16, 2, v16
  v_and_b32 v17, 7, v16
  v_xor_b32 v17, s78, v17
  v_lshl_add_u32 v203, v17, 4, v18
  buffer_load_dwordx4 v235, s[4:7], s70 offen lds
  v_xor_b32 v207, 64, v203
  v_add_u32 v16, 2, v16
  v_and_b32 v17, 7, v16
  v_xor_b32 v17, s78, v17
  v_lshl_add_u32 v205, v17, 4, v18
  v_xor_b32 v209, 64, v205
  v_lshl_add_u32 v16, v6, 2, v5
  v_lshrrev_b32 v17, 4, v16
  v_add_u32 v17, 4, v17
  v_xor_b32 v17, s15, v17
  v_lshlrev_b32 v17, 4, v17
  v_and_b32 v18, 7, v16
  v_lshl_add_u32 v17, v18, 1, v17
  v_lshrrev_b32 v16, 3, v16
  v_lshl_add_u32 v17, v16, 7, v17
  s_and_b32 s78, s61, 1
  s_lshl_b32 s78, s78, 12
  s_add_u32 s78, s78, 148736
  v_add_u32 v210, s78, v17
  v_and_b32 v16, 3, v6
  v_lshlrev_b32 v16, 4, v16
  v_lshrrev_b32 v17, 2, v6
  v_lshl_add_u32 v16, v17, 7, v16
  v_lshl_add_u32 v16, v1, 6, v16
  v_and_b32 v17, 1, v5
  v_lshl_add_u32 v211, v17, 9, v16
  v_add_u32 v16, -16, v255
  v_add_u32 v17, -1, v255
  v_and_b32 v17, 15, v17
  v_cmp_gt_u32 vcc, 16, v255
  v_add_u32 v17, 48, v17
  s_nop 0
  v_cndmask_b32 v16, v16, v17, vcc
  v_lshlrev_b32 v212, 2, v16
  v_add_u32 v213, s28, v252
  v_add_u32 v214, s29, v252
  v_xor_b32 v176, 0, v210
  v_xor_b32 v177, 16, v210
  v_xor_b32 v178, 32, v210
  v_xor_b32 v179, 48, v210
  v_xor_b32 v180, 64, v210
  v_xor_b32 v181, 80, v210
  v_xor_b32 v182, 96, v210
  v_xor_b32 v183, 112, v210
  s_lshl2_add_u32 s15, s61, 160000
  v_mov_b32 v184, s15
  v_xor_b32 v185, 4, v184
  s_bfe_u32 s71, s66, 0x30004
  s_lshl_b32 s70, s71, 7
  s_mul_i32 s71, s71, 229376
  s_add_u32 m0, s69, 49152
  s_nop 0
  buffer_load_dwordx4 v236, s[24:27], s71 offen lds
  s_add_u32 m0, s69, 32768
  s_nop 0
  buffer_load_dwordx4 v232, s[4:7], s70 offen lds
  s_add_u32 m0, s69, 53248
  s_nop 0
  buffer_load_dwordx4 v237, s[24:27], s71 offen lds
  s_add_u32 m0, s69, 36864
  s_nop 0
  buffer_load_dwordx4 v233, s[4:7], s70 offen lds
  s_add_u32 m0, s69, 57344
  s_nop 0
  buffer_load_dwordx4 v238, s[24:27], s71 offen lds
  s_add_u32 m0, s69, 40960
  s_nop 0
  buffer_load_dwordx4 v234, s[4:7], s70 offen lds
  s_add_u32 m0, s69, 61440
  s_nop 0
  buffer_load_dwordx4 v239, s[24:27], s71 offen lds
  s_add_u32 m0, s69, 45056
  s_nop 0
  buffer_load_dwordx4 v235, s[4:7], s70 offen lds
  s_waitcnt vmcnt(8)
  s_barrier
  s_cmp_lg_u32 s61, 0
  s_cbranch_scc1 L_nD0
  s_load_dword s12, s[44:45], 0
L_nD0:
  s_bfe_u32 s71, s66, 0x30008
  s_lshl_b32 s70, s71, 7
  s_mul_i32 s71, s71, 229376
  s_add_u32 m0, s69, 81920
  s_nop 0
  buffer_load_dwordx4 v236, s[24:27], s71 offen lds
  s_add_u32 m0, s69, 65536
  s_nop 0
  buffer_load_dwordx4 v232, s[4:7], s70 offen lds
  s_add_u32 m0, s69, 86016
  s_nop 0
  buffer_load_dwordx4 v237, s[24:27], s71 offen lds
  s_add_u32 m0, s69, 69632
  s_nop 0
  buffer_load_dwordx4 v233, s[4:7], s70 offen lds
  s_add_u32 m0, s69, 90112
  s_nop 0
  buffer_load_dwordx4 v238, s[24:27], s71 offen lds
  s_add_u32 m0, s69, 73728
  s_nop 0
  buffer_load_dwordx4 v234, s[4:7], s70 offen lds
  s_add_u32 m0, s69, 94208
  s_nop 0
  buffer_load_dwordx4 v239, s[24:27], s71 offen lds
  s_add_u32 m0, s69, 77824
  s_nop 0
  buffer_load_dwordx4 v235, s[4:7], s70 offen lds
  s_bfe_u32 s71, s66, 0x3000c
  s_lshl_b32 s70, s71, 7
  s_mul_i32 s71, s71, 229376
  s_add_u32 m0, s69, 114688
  s_nop 0
  buffer_load_dwordx4 v236, s[24:27], s71 offen lds
  s_add_u32 m0, s69, 98304
  s_nop 0
  buffer_load_dwordx4 v232, s[4:7], s70 offen lds
  s_cmp_lg_u32 s61, 0
  s_cbranch_scc1 L_pollD_ok
  s_mov_b32 s72, 0
L_pollD:
  s_waitcnt lgkmcnt(0)
  s_cmp_ge_u32 s12, 1
  s_cbranch_scc1 L_pollD_ok
L_pollD_re:
  s_add_u32 s72, s72, 1
  s_cmp_ge_u32 s72, 50000
  s_cbranch_scc1 L_pollD_ok
  s_sleep 8
  buffer_load_dword v24, v254, s[44:47], 0 offen sc1
  s_waitcnt vmcnt(0)
  v_readfirstlane_b32 s12, v24
  s_branch L_pollD
L_pollD_ok:
  s_bfe_u32 s63, s66, 0x30000
  s_cmp_lg_u32 s63, s31
  s_cbranch_scc1 L_xg0
  ds_read_b128 v[216:219], v244 offset:0
  ds_read_b128 v[220:223], v244 offset:4096
  ds_read_b32 v246, v244
  s_waitcnt lgkmcnt(1)
L_xg0:
  s_waitcnt vmcnt(10)
  s_barrier
  s_cmp_lg_u32 s61, 1
  s_cbranch_scc1 L_sigT
  s_mov_b32 s17, 1
  s_atomic_add s17, s[48:49], s16
L_sigT:
  s_cmp_lg_u32 s61, 0
  s_cbranch_scc1 L_sigS
  s_waitcnt lgkmcnt(0)
  s_mov_b32 s17, 4
  s_atomic_add s17, s[48:49], s8
L_sigS:
  s_lshl_b32 s63, s60, 12
  s_and_b32 s64, s61, 1
  s_mul_i32 s65, s61, 4144
  s_lshl2_add_u32 s64, s64, s65
  s_add_u32 m0, s64, 131104
  s_nop 0
  buffer_load_dwordx4 v252, s[20:23], s63 offen offset:0 lds
  buffer_load_dwordx4 v252, s[20:23], s63 offen offset:1024 lds
  buffer_load_dwordx4 v252, s[20:23], s63 offen offset:2048 lds
  buffer_load_dwordx4 v252, s[20:23], s63 offen offset:3072 lds
  s_add_u32 m0, s69, 118784
  s_nop 0
  buffer_load_dwordx4 v237, s[24:27], s71 offen lds
  s_add_u32 m0, s69, 102400
  s_nop 0
  buffer_load_dwordx4 v233, s[4:7], s70 offen lds
  s_add_u32 m0, s69, 122880
  s_nop 0
  buffer_load_dwordx4 v238, s[24:27], s71 offen lds
  s_add_u32 m0, s69, 106496
  s_nop 0
  buffer_load_dwordx4 v234, s[4:7], s70 offen lds
  s_add_u32 m0, s69, 126976
  s_nop 0
  buffer_load_dwordx4 v239, s[24:27], s71 offen lds
  s_add_u32 m0, s69, 110592
  s_nop 0
  buffer_load_dwordx4 v235, s[4:7], s70 offen lds
  s_bfe_u32 s71, s66, 0x30010
  s_lshl_b32 s70, s71, 7
  s_mul_i32 s71, s71, 229376
  s_add_u32 m0, s69, 16384
  s_nop 0
  buffer_load_dwordx4 v236, s[24:27], s71 offen lds
  s_add_u32 m0, s69, 0
  s_nop 0
  buffer_load_dwordx4 v232, s[4:7], s70 offen lds
  s_bfe_u32 s63, s66, 0x30004
  s_cmp_lg_u32 s63, s31
  s_cbranch_scc1 L_xg1
  ds_read_b128 v[216:219], v244 offset:32768
  ds_read_b128 v[220:223], v244 offset:36864
  ds_read_b32 v246, v244
  s_waitcnt lgkmcnt(1)
L_xg1:
  s_waitcnt vmcnt(14)
  s_barrier
  s_add_u32 m0, s69, 20480
  s_nop 0
  buffer_load_dwordx4 v237, s[24:27], s71 offen lds
  s_add_u32 m0, s69, 4096
  s_nop 0
  buffer_load_dwordx4 v233, s[4:7], s70 offen lds
  s_add_u32 m0, s69, 24576
  s_nop 0
  buffer_load_dwordx4 v238, s[24:27], s71 offen lds
  s_add_u32 m0, s69, 8192
  s_nop 0
  buffer_load_dwordx4 v234, s[4:7], s70 offen lds
  s_add_u32 m0, s69, 28672
  s_nop 0
  buffer_load_dwordx4 v239, s[24:27], s71 offen lds
  s_add_u32 m0, s69, 12288
  s_nop 0
  buffer_load_dwordx4 v235, s[4:7], s70 offen lds
  s_bfe_u32 s71, s66, 0x30014
  s_lshl_b32 s70, s71, 7
  s_mul_i32 s71, s71, 229376
  s_add_u32 m0, s69, 49152
  s_nop 0
  buffer_load_dwordx4 v236, s[24:27], s71 offen lds
  s_add_u32 m0, s69, 32768
  s_nop 0
  buffer_load_dwordx4 v232, s[4:7], s70 offen lds
  s_bfe_u32 s63, s66, 0x30008
  s_cmp_lg_u32 s63, s31
  s_cbranch_scc1 L_xg2
  ds_read_b128 v[216:219], v245 offset:0
  ds_read_b128 v[220:223], v245 offset:4096
  ds_read_b32 v246, v244
  s_waitcnt lgkmcnt(1)
L_xg2:
  s_waitcnt vmcnt(10)
  s_barrier
  s_add_u32 m0, s69, 53248
  s_nop 0
  buffer_load_dwordx4 v237, s[24:27], s71 offen lds
  s_add_u32 m0, s69, 36864
  s_nop 0
  buffer_load_dwordx4 v233, s[4:7], s70 offen lds
  s_add_u32 m0, s69, 57344
  s_nop 0
  buffer_load_dwordx4 v238, s[24:27], s71 offen lds
  s_add_u32 m0, s69, 40960
  s_nop 0
  buffer_load_dwordx4 v234, s[4:7], s70 offen lds
  s_add_u32 m0, s69, 61440
  s_nop 0
  buffer_load_dwordx4 v239, s[24:27], s71 offen lds
  s_add_u32 m0, s69, 45056
  s_nop 0
  buffer_load_dwordx4 v235, s[4:7], s70 offen lds
  s_bfe_u32 s71, s66, 0x30018
  s_lshl_b32 s70, s71, 7
  s_mul_i32 s71, s71, 229376
  s_add_u32 m0, s69, 81920
  s_nop 0
  buffer_load_dwordx4 v236, s[24:27], s71 offen lds
  s_add_u32 m0, s69, 65536
  s_nop 0
  buffer_load_dwordx4 v232, s[4:7], s70 offen lds
  s_bfe_u32 s63, s66, 0x3000c
  s_cmp_lg_u32 s63, s31
  s_cbranch_scc1 L_xg3
  ds_read_b128 v[216:219], v245 offset:32768
  ds_read_b128 v[220:223], v245 offset:36864
  ds_read_b32 v246, v244
  s_waitcnt lgkmcnt(1)
L_xg3:
  s_waitcnt vmcnt(10)
  s_barrier
  s_add_u32 m0, s69, 86016
  s_nop 0
  buffer_load_dwordx4 v237, s[24:27], s71 offen lds
  s_add_u32 m0, s69, 69632
  s_nop 0
  buffer_load_dwordx4 v233, s[4:7], s70 offen lds
  s_add_u32 m0, s69, 90112
  s_nop 0
  buffer_load_dwordx4 v238, s[24:27], s71 offen lds
  s_add_u32 m0, s69, 73728
  s_nop 0
  buffer_load_dwordx4 v234, s[4:7], s70 offen lds
  s_add_u32 m0, s69, 94208
  s_nop 0
  buffer_load_dwordx4 v239, s[24:27], s71 offen lds
  s_add_u32 m0, s69, 77824
  s_nop 0
  buffer_load_dwordx4 v235, s[4:7], s70 offen lds
  s_bfe_u32 s71, s66, 0x3001c
  s_lshl_b32 s70, s71, 7
  s_mul_i32 s71, s71, 229376
  s_add_u32 m0, s69, 114688
  s_nop 0
  buffer_load_dwordx4 v236, s[24:27], s71 offen lds
  s_add_u32 m0, s69, 98304
  s_nop 0
  buffer_load_dwordx4 v232, s[4:7], s70 offen lds
  s_bfe_u32 s63, s66, 0x30010
  s_cmp_lg_u32 s63, s31
  s_cbranch_scc1 L_xg4
  ds_read_b128 v[216:219], v244 offset:0
  ds_read_b128 v[220:223], v244 offset:4096
  ds_read_b32 v246, v244
  s_waitcnt lgkmcnt(1)
L_xg4:
  s_waitcnt vmcnt(10)
  s_barrier
  s_add_u32 m0, s69, 118784
  s_nop 0
  buffer_load_dwordx4 v237, s[24:27], s71 offen lds
  s_add_u32 m0, s69, 102400
  s_nop 0
  buffer_load_dwordx4 v233, s[4:7], s70 offen lds
  s_add_u32 m0, s69, 122880
  s_nop 0
  buffer_load_dwordx4 v238, s[24:27], s71 offen lds
  s_add_u32 m0, s69, 106496
  s_nop 0
  buffer_load_dwordx4 v234, s[4:7], s70 offen lds
  s_add_u32 m0, s69, 126976
  s_nop 0
  buffer_load_dwordx4 v239, s[24:27], s71 offen lds
  s_add_u32 m0, s69, 110592
  s_nop 0
  buffer_load_dwordx4 v235, s[4:7], s70 offen lds
  s_cmp_lg_u32 s61, 2
  s_cbranch_scc1 L_n10
  s_load_dword s12, s[48:49], s9
  s_load_dword s13, s[48:49], s10
L_n10:
  s_add_u32 m0, s69, 0
  s_add_u32 s65, s73, 0
  buffer_load_dwordx4 v240, s[32:35], s65 offen lds
  s_add_u32 m0, s69, 4096
  s_add_u32 s65, s73, 65536
  buffer_load_dwordx4 v240, s[32:35], s65 offen lds
  s_bfe_u32 s63, s66, 0x30014
  s_cmp_lg_u32 s63, s31
  s_cbranch_scc1 L_xg5
  ds_read_b128 v[216:219], v244 offset:32768
  ds_read_b128 v[220:223], v244 offset:36864
  ds_read_b32 v246, v244
  s_waitcnt lgkmcnt(1)
L_xg5:
  s_waitcnt vmcnt(10)
  s_barrier
  s_cmp_lg_u32 s61, 2
  s_cbranch_scc1 L_n11
  s_mov_b32 s72, 0
L_poll1:
  s_waitcnt lgkmcnt(0)
  s_cmp_lt_u32 s12, 64
  s_cbranch_scc1 L_poll1_re
  s_cmp_ge_u32 s13, 2
  s_cbranch_scc1 L_poll1_ok
L_poll1_re:
  s_add_u32 s72, s72, 1
  s_cmp_ge_u32 s72, 50000
  s_cbranch_scc1 L_poll1_ok
  s_sleep 4
  buffer_load_dword v24, v254, s[48:51], s9 offen sc1
  buffer_load_dword v25, v254, s[48:51], s10 offen sc1
  s_waitcnt vmcnt(0)
  v_readfirstlane_b32 s12, v24
  v_readfirstlane_b32 s13, v25
  s_branch L_poll1
L_poll1_ok:
  s_lshl_b32 s63, s58, 11
  s_add_u32 s63, s63, 32768
  s_lshl_b32 s64, s59, 10
  s_mov_b32 m0, 156928
  s_add_u32 s64, s64, 63488
  buffer_load_dwordx4 v252, s[48:51], s63 offen sc1 lds
  buffer_load_dwordx4 v252, s[48:51], s63 offen offset:1024 sc1 lds
  buffer_load_dwordx4 v252, s[48:51], s64 offen offset:2048 sc1 lds
L_n11:
  s_add_u32 m0, s69, 8192
  s_add_u32 s65, s73, 131072
  buffer_load_dwordx4 v240, s[32:35], s65 offen lds
  s_add_u32 m0, s69, 12288
  s_add_u32 s65, s73, 196608
  buffer_load_dwordx4 v240, s[32:35], s65 offen lds
  s_add_u32 m0, s69, 16384
  s_add_u32 s65, s74, 0
  buffer_load_dwordx4 v240, s[32:35], s65 offen lds
  s_add_u32 m0, s69, 20480
  s_add_u32 s65, s74, 65536
  buffer_load_dwordx4 v240, s[32:35], s65 offen lds
  s_add_u32 m0, s69, 24576
  s_add_u32 s65, s74, 131072
  buffer_load_dwordx4 v240, s[32:35], s65 offen lds
  s_add_u32 m0, s69, 28672
  s_add_u32 s65, s74, 196608
  buffer_load_dwordx4 v240, s[32:35], s65 offen lds
  s_bfe_u32 s63, s66, 0x30018
  s_cmp_lg_u32 s63, s31
  s_cbranch_scc1 L_xg6
  ds_read_b128 v[216:219], v245 offset:0
  ds_read_b128 v[220:223], v245 offset:4096
  ds_read_b32 v246, v244
  s_waitcnt lgkmcnt(1)
L_xg6:
  s_waitcnt vmcnt(11)
  s_cmp_eq_u32 s61, 2
  s_cbranch_scc1 L_xw8
  s_waitcnt vmcnt(8)
L_xw8:
  s_barrier
  s_add_u32 m0, s69, 32768
  s_add_u32 s65, s75, 0
  buffer_load_dwordx4 v240, s[32:35], s65 offen lds
  s_add_u32 m0, s69, 36864
  s_add_u32 s65, s75, 65536
  buffer_load_dwordx4 v240, s[32:35], s65 offen lds
  s_add_u32 m0, s69, 40960
  s_add_u32 s65, s75, 131072
  buffer_load_dwordx4 v240, s[32:35], s65 offen lds
  s_add_u32 m0, s69, 45056
  s_add_u32 s65, s75, 196608
  buffer_load_dwordx4 v240, s[32:35], s65 offen lds
  s_add_u32 m0, s69, 49152
  s_add_u32 s65, s76, 0
  buffer_load_dwordx4 v240, s[32:35], s65 offen lds
  s_add_u32 m0, s69, 53248
  s_add_u32 s65, s76, 65536
  buffer_load_dwordx4 v240, s[32:35], s65 offen lds
  s_bfe_u32 s63, s66, 0x3001c
  s_cmp_lg_u32 s63, s31
  s_cbranch_scc1 L_xg7
  ds_read_b128 v[216:219], v245 offset:32768
  ds_read_b128 v[220:223], v245 offset:36864
  ds_read_b32 v246, v244
  s_waitcnt lgkmcnt(1)
L_xg7:
  s_waitcnt vmcnt(12)
L_C_join:
  s_barrier
  s_waitcnt vmcnt(7)
  s_add_u32 m0, s69, 57344
  s_add_u32 s65, s76, 131072
  buffer_load_dwordx4 v240, s[32:35], s65 offen lds
  s_waitcnt vmcnt(7)
  s_add_u32 m0, s69, 61440
  s_add_u32 s65, s76, 196608
  buffer_load_dwordx4 v240, s[32:35], s65 offen lds
  s_waitcnt vmcnt(7)
  s_add_u32 m0, s69, 65536
  s_add_u32 s65, s73, 262144
  buffer_load_dwordx4 v240, s[32:35], s65 offen lds
  s_waitcnt vmcnt(7)
  s_add_u32 m0, s69, 69632
  s_add_u32 s65, s73, 327680
  buffer_load_dwordx4 v240, s[32:35], s65 offen lds
  s_waitcnt vmcnt(7)
  s_add_u32 m0, s69, 73728
  s_add_u32 s65, s73, 393216
  buffer_load_dwordx4 v240, s[32:35], s65 offen lds
  s_waitcnt vmcnt(7)
  s_add_u32 m0, s69, 77824
  s_add_u32 s65, s74, 262144
  buffer_load_dwordx4 v240, s[32:35], s65 offen lds
  s_load_dword s12, s[48:49], s11
  s_load_dword s13, s[48:49], s18
  s_waitcnt vmcnt(7)
  s_add_u32 m0, s69, 81920
  s_add_u32 s65, s74, 327680
  buffer_load_dwordx4 v240, s[32:35], s65 offen lds
  s_waitcnt vmcnt(7)
  s_add_u32 m0, s69, 86016
  s_add_u32 s65, s74, 393216
  buffer_load_dwordx4 v240, s[32:35], s65 offen lds
  s_lshl_b32 s63, s54, 5
  s_add_u32 s63, s63, s55
  s_mul_i32 s63, s63, 8320
  s_lshl1_add_u32 s63, s69, s63
  s_add_u32 s63, s63, 262144
  s_mov_b32 s72, 0
L_pollU:
  s_waitcnt lgkmcnt(0)
  s_cmp_lt_u32 s12, 32
  s_cbranch_scc1 L_pollU_re
  s_cmp_ge_u32 s13, 32
  s_cbranch_scc1 L_pollU_ok
L_pollU_re:
  s_add_u32 s72, s72, 1
  s_cmp_ge_u32 s72, 50000
  s_cbranch_scc1 L_pollU_ok
  s_sleep 4
  buffer_load_dword v24, v254, s[48:51], s11 offen sc1
  buffer_load_dword v25, v254, s[48:51], s18 offen sc1
  s_waitcnt vmcnt(0)
  v_readfirstlane_b32 s12, v24
  v_readfirstlane_b32 s13, v25
  s_branch L_pollU
L_pollU_ok:
  s_lshl1_add_u32 m0, s69, 148736
  s_nop 0
  buffer_load_dwordx4 v242, s[48:51], s63 offen offset:0 sc1 lds
  buffer_load_dwordx4 v243, s[48:51], s63 offen offset:1024 sc1 lds
  s_waitcnt vmcnt(7)
  s_add_u32 m0, s69, 98304
  s_add_u32 s65, s75, 262144
  buffer_load_dwordx4 v240, s[32:35], s65 offen lds
  s_waitcnt vmcnt(7)
  s_add_u32 m0, s69, 102400
  s_add_u32 s65, s75, 327680
  buffer_load_dwordx4 v240, s[32:35], s65 offen lds
  s_waitcnt vmcnt(7)
  s_add_u32 m0, s69, 106496
  s_add_u32 s65, s75, 393216
  buffer_load_dwordx4 v240, s[32:35], s65 offen lds
  s_waitcnt vmcnt(7)
  s_add_u32 m0, s69, 110592
  s_add_u32 s65, s76, 262144
  buffer_load_dwordx4 v240, s[32:35], s65 offen lds
  s_waitcnt vmcnt(7)
  s_add_u32 m0, s69, 114688
  s_add_u32 s65, s76, 327680
  buffer_load_dwordx4 v240, s[32:35], s65 offen lds
  s_waitcnt vmcnt(7)
  s_add_u32 m0, s69, 118784
  s_add_u32 s65, s76, 393216
  buffer_load_dwordx4 v240, s[32:35], s65 offen lds
  ds_read_b64_tr_b16 v[32:33], v200 offset:288
  ds_read_b64_tr_b16 v[34:35], v200 offset:256
  ds_read_b64_tr_b16 v[36:37], v200 offset:800
  ds_read_b64_tr_b16 v[38:39], v200 offset:768
  ds_read_b64_tr_b16 v[40:41], v200 offset:1312
  ds_read_b64_tr_b16 v[42:43], v200 offset:1280
  ds_read_b64_tr_b16 v[44:45], v200 offset:1824
  ds_read_b64_tr_b16 v[46:47], v200 offset:1792
  ds_read_b64_tr_b16 v[48:49], v200 offset:2336
  ds_read_b64_tr_b16 v[50:51], v200 offset:2304
  ds_read_b64_tr_b16 v[52:53], v200 offset:2848
  ds_read_b64_tr_b16 v[54:55], v200 offset:2816
  ds_read_b64_tr_b16 v[56:57], v200 offset:3360
  ds_read_b64_tr_b16 v[58:59], v200 offset:3328
  ds_read_b64_tr_b16 v[60:61], v200 offset:3872
  ds_read_b64_tr_b16 v[62:63], v200 offset:3840
  ds_read_b64_tr_b16 v[96:97], v200 offset:32
  ds_read_b64_tr_b16 v[98:99], v200 offset:0
  ds_read_b64_tr_b16 v[100:101], v200 offset:544
  ds_read_b64_tr_b16 v[102:103], v200 offset:512
  ds_read_b64_tr_b16 v[104:105], v200 offset:1056
  ds_read_b64_tr_b16 v[106:107], v200 offset:1024
  ds_read_b64_tr_b16 v[108:109], v200 offset:1568
  ds_read_b64_tr_b16 v[110:111], v200 offset:1536
  ds_read_b64_tr_b16 v[112:113], v200 offset:2080
  ds_read_b64_tr_b16 v[114:115], v200 offset:2048
  ds_read_b64_tr_b16 v[116:117], v200 offset:2592
  ds_read_b64_tr_b16 v[118:119], v200 offset:2560
  ds_read_b64_tr_b16 v[120:121], v200 offset:3104
  ds_read_b64_tr_b16 v[122:123], v200 offset:3072
  ds_read_b64_tr_b16 v[124:125], v200 offset:3616
  ds_read_b64_tr_b16 v[126:127], v200 offset:3584
  s_lshl_b32 s63, s68, 16
  s_and_b32 s64, s68, 0xffff0000
  s_bitcmp1_b32 s60, 0
  s_cselect_b32 s68, s64, s63
  s_and_b32 s64, s69, 1024
  s_mul_i32 s62, s60, 4224
  s_lshl1_add_u32 s62, s64, s62
  s_add_u32 s62, s62, 2621440
  s_mov_b32 vcc_lo, 0
  s_mov_b32 vcc_hi, 0x80000000
  s_mov_b32 s72, 0
  s_waitcnt vmcnt(6)
  s_barrier
  ds_read_b64 v[64:65], v202 offset:0
  ds_read_b64 v[66:67], v203 offset:0
  ds_read_b64 v[68:69], v206 offset:1024
  ds_read_b64 v[70:71], v207 offset:1024
  ds_read_b64 v[72:73], v202 offset:2048
  ds_read_b64 v[74:75], v203 offset:2048
  ds_read_b64 v[76:77], v206 offset:3072
  ds_read_b64 v[78:79], v207 offset:3072
  ds_read_b64 v[80:81], v202 offset:4096
  ds_read_b64 v[82:83], v203 offset:4096
  ds_read_b64 v[84:85], v206 offset:5120
  ds_read_b64 v[86:87], v207 offset:5120
  ds_read_b64 v[88:89], v202 offset:6144
  ds_read_b64 v[90:91], v203 offset:6144
  ds_read_b64 v[92:93], v206 offset:7168
  ds_read_b64 v[94:95], v207 offset:7168
  ds_read_b64 v[128:129], v204 offset:512
  ds_read_b64 v[130:131], v205 offset:512
  ds_read_b64 v[132:133], v208 offset:1536
  ds_read_b64 v[134:135], v209 offset:1536
  ds_read_b64 v[136:137], v204 offset:2560
  ds_read_b64 v[138:139], v205 offset:2560
  ds_read_b64 v[140:141], v208 offset:3584
  ds_read_b64 v[142:143], v209 offset:3584
  ds_read_b64 v[144:145], v204 offset:4608
  ds_read_b64 v[146:147], v205 offset:4608
  ds_read_b64 v[148:149], v208 offset:5632
  ds_read_b64 v[150:151], v209 offset:5632
  ds_read_b64 v[152:153], v204 offset:6656
  ds_read_b64 v[154:155], v205 offset:6656
  ds_read_b64 v[156:157], v208 offset:7680
  ds_read_b64 v[158:159], v209 offset:7680
  s_barrier
  s_setprio 1
  s_waitcnt lgkmcnt(15)
  v_mfma_f32_16x16x32_bf16 v[0:3], v[32:35], v[64:67], 0
  ds_read_u16_d16_hi v160, v176 offset:0
  v_mfma_f32_16x16x32_bf16 v[4:7], v[36:39], v[64:67], 0
  ds_read_u16_d16_hi v161, v177 offset:0
  v_mfma_f32_16x16x32_bf16 v[4:7], v[32:35], v[68:71], v[4:7]
  v_mfma_f32_16x16x32_bf16 v[8:11], v[40:43], v[64:67], 0
  ds_read_u16_d16_hi v162, v178 offset:0
  v_mfma_f32_16x16x32_bf16 v[8:11], v[36:39], v[68:71], v[8:11]
  ds_read_u16_d16_hi v163, v179 offset:0
  v_mfma_f32_16x16x32_bf16 v[8:11], v[32:35], v[72:75], v[8:11]
  v_mfma_f32_16x16x32_bf16 v[12:15], v[44:47], v[64:67], 0
L_warm_d0:
  s_cbranch_execz L_warm_ret
  s_nop 0
  ds_read_u16_d16_hi v164, v180 offset:1024
  v_mfma_f32_16x16x32_bf16 v[12:15], v[40:43], v[68:71], v[12:15]
  ds_read_u16_d16_hi v165, v181 offset:1024
  v_mfma_f32_16x16x32_bf16 v[12:15], v[36:39], v[72:75], v[12:15]
  v_mfma_f32_16x16x32_bf16 v[12:15], v[32:35], v[76:79], v[12:15]
  ds_read_u16_d16_hi v166, v182 offset:1024
  v_mfma_f32_16x16x32_bf16 v[16:19], v[48:51], v[64:67], 0
  ds_read_u16_d16_hi v167, v183 offset:1024
  v_mfma_f32_16x16x32_bf16 v[16:19], v[44:47], v[68:71], v[16:19]
  v_mfma_f32_16x16x32_bf16 v[16:19], v[40:43], v[72:75], v[16:19]
  ds_read_u16_d16_hi v168, v176 offset:2048
  v_mfma_f32_16x16x32_bf16 v[16:19], v[36:39], v[76:79], v[16:19]
  ds_read_u16_d16_hi v169, v177 offset:2048
  v_mfma_f32_16x16x32_bf16 v[16:19], v[32:35], v[80:83], v[16:19]
  v_mfma_f32_16x16x32_bf16 v[20:23], v[52:55], v[64:67], 0
  ds_read_u16_d16_hi v170, v178 offset:2048
  v_mfma_f32_16x16x32_bf16 v[20:23], v[48:51], v[68:71], v[20:23]
  ds_read_u16_d16_hi v171, v179 offset:2048
  v_mfma_f32_16x16x32_bf16 v[20:23], v[44:47], v[72:75], v[20:23]
  v_mfma_f32_16x16x32_bf16 v[20:23], v[40:43], v[76:79], v[20:23]
  ds_read_u16_d16_hi v172, v180 offset:3072
  v_mfma_f32_16x16x32_bf16 v[20:23], v[36:39], v[80:83], v[20:23]
  ds_read_u16_d16_hi v173, v181 offset:3072
  v_mfma_f32_16x16x32_bf16 v[20:23], v[32:35], v[84:87], v[20:23]
  v_mfma_f32_16x16x32_bf16 v[24:27], v[56:59], v[64:67], 0
  ds_read_u16_d16_hi v174, v182 offset:3072
  v_mfma_f32_16x16x32_bf16 v[24:27], v[52:55], v[68:71], v[24:27]
  ds_read_u16_d16_hi v175, v183 offset:3072
  v_mfma_f32_16x16x32_bf16 v[24:27], v[48:51], v[72:75], v[24:27]
  v_mfma_f32_16x16x32_bf16 v[24:27], v[44:47], v[76:79], v[24:27]
  v_xor_b32 v202, 32, v202
  v_mfma_f32_16x16x32_bf16 v[24:27], v[40:43], v[80:83], v[24:27]
  v_xor_b32 v203, 32, v203
  v_mfma_f32_16x16x32_bf16 v[24:27], v[36:39], v[84:87], v[24:27]
  v_mfma_f32_16x16x32_bf16 v[24:27], v[32:35], v[88:91], v[24:27]
  v_xor_b32 v204, 32, v204
  v_mfma_f32_16x16x32_bf16 v[28:31], v[60:63], v[64:67], 0
  v_xor_b32 v205, 32, v205
  v_mfma_f32_16x16x32_bf16 v[28:31], v[56:59], v[68:71], v[28:31]
  v_mfma_f32_16x16x32_bf16 v[28:31], v[52:55], v[72:75], v[28:31]
  v_xor_b32 v206, 32, v206
  v_mfma_f32_16x16x32_bf16 v[28:31], v[48:51], v[76:79], v[28:31]
  v_xor_b32 v207, 32, v207
  v_mfma_f32_16x16x32_bf16 v[28:31], v[44:47], v[80:83], v[28:31]
  v_mfma_f32_16x16x32_bf16 v[28:31], v[40:43], v[84:87], v[28:31]
  v_xor_b32 v208, 32, v208
  v_mfma_f32_16x16x32_bf16 v[28:31], v[36:39], v[88:91], v[28:31]
  v_xor_b32 v209, 32, v209
  v_mfma_f32_16x16x32_bf16 v[28:31], v[32:35], v[92:95], v[28:31]
  s_waitcnt lgkmcnt(15)
  v_mfma_f32_16x16x32_bf16 v[0:3], v[96:99], v[128:131], v[0:3]
  ds_read_b64 v[64:65], v202 offset:0
  v_mfma_f32_16x16x32_bf16 v[4:7], v[100:103], v[128:131], v[4:7]
  ds_read_b64 v[66:67], v203 offset:0
  v_mfma_f32_16x16x32_bf16 v[4:7], v[96:99], v[132:135], v[4:7]
  ds_read_b64_tr_b16 v[32:33], v201 offset:288
  v_mfma_f32_16x16x32_bf16 v[8:11], v[104:107], v[128:131], v[8:11]
  ds_read_b64_tr_b16 v[34:35], v201 offset:256
  v_mfma_f32_16x16x32_bf16 v[8:11], v[100:103], v[132:135], v[8:11]
  ds_read_b64 v[68:69], v206 offset:1024
  s_waitcnt vmcnt(0)
  s_barrier
  v_mfma_f32_16x16x32_bf16 v[8:11], v[96:99], v[136:139], v[8:11]
  ds_read_b64 v[70:71], v207 offset:1024
  v_mfma_f32_16x16x32_bf16 v[12:15], v[108:111], v[128:131], v[12:15]
  ds_read_b64_tr_b16 v[36:37], v201 offset:800
  v_mfma_f32_16x16x32_bf16 v[12:15], v[104:107], v[132:135], v[12:15]
  ds_read_b64_tr_b16 v[38:39], v201 offset:768
  v_mfma_f32_16x16x32_bf16 v[12:15], v[100:103], v[136:139], v[12:15]
  v_mfma_f32_16x16x32_bf16 v[12:15], v[96:99], v[140:143], v[12:15]
  ds_read_b64 v[72:73], v202 offset:2048
  v_mfma_f32_16x16x32_bf16 v[16:19], v[112:115], v[128:131], v[16:19]
  ds_read_b64 v[74:75], v203 offset:2048
  v_mfma_f32_16x16x32_bf16 v[16:19], v[108:111], v[132:135], v[16:19]
  ds_read_b64_tr_b16 v[40:41], v201 offset:1312
  v_mfma_f32_16x16x32_bf16 v[16:19], v[104:107], v[136:139], v[16:19]
  ds_read_b64_tr_b16 v[42:43], v201 offset:1280
  v_mfma_f32_16x16x32_bf16 v[16:19], v[100:103], v[140:143], v[16:19]
  ds_read_b64 v[76:77], v206 offset:3072
  v_mfma_f32_16x16x32_bf16 v[16:19], v[96:99], v[144:147], v[16:19]
  ds_read_b64 v[78:79], v207 offset:3072
  v_mfma_f32_16x16x32_bf16 v[20:23], v[116:119], v[128:131], v[20:23]
  ds_read_b64_tr_b16 v[44:45], v201 offset:1824
  v_mfma_f32_16x16x32_bf16 v[20:23], v[112:115], v[132:135], v[20:23]
  ds_read_b64_tr_b16 v[46:47], v201 offset:1792
  v_mfma_f32_16x16x32_bf16 v[20:23], v[108:111], v[136:139], v[20:23]
  v_mfma_f32_16x16x32_bf16 v[20:23], v[104:107], v[140:143], v[20:23]
  ds_read_b64 v[80:81], v202 offset:4096
  v_mfma_f32_16x16x32_bf16 v[20:23], v[100:103], v[144:147], v[20:23]
  ds_read_b64 v[82:83], v203 offset:4096
  v_mfma_f32_16x16x32_bf16 v[20:23], v[96:99], v[148:151], v[20:23]
  ds_read_b64_tr_b16 v[48:49], v201 offset:2336
  v_mfma_f32_16x16x32_bf16 v[24:27], v[120:123], v[128:131], v[24:27]
  ds_read_b64_tr_b16 v[50:51], v201 offset:2304
  v_mfma_f32_16x16x32_bf16 v[24:27], v[116:119], v[132:135], v[24:27]
  ds_read_b64 v[84:85], v206 offset:5120
  v_mfma_f32_16x16x32_bf16 v[24:27], v[112:115], v[136:139], v[24:27]
  ds_read_b64 v[86:87], v207 offset:5120
  v_mfma_f32_16x16x32_bf16 v[24:27], v[108:111], v[140:143], v[24:27]
  ds_read_b64_tr_b16 v[52:53], v201 offset:2848
  v_mfma_f32_16x16x32_bf16 v[24:27], v[104:107], v[144:147], v[24:27]
  ds_read_b64_tr_b16 v[54:55], v201 offset:2816
  v_mfma_f32_16x16x32_bf16 v[24:27], v[100:103], v[148:151], v[24:27]
  v_mfma_f32_16x16x32_bf16 v[24:27], v[96:99], v[152:155], v[24:27]
  ds_read_b64 v[88:89], v202 offset:6144
  v_mfma_f32_16x16x32_bf16 v[28:31], v[124:127], v[128:131], v[28:31]
  ds_read_b64 v[90:91], v203 offset:6144
  v_mfma_f32_16x16x32_bf16 v[28:31], v[120:123], v[132:135], v[28:31]
  ds_read_b64_tr_b16 v[56:57], v201 offset:3360
  v_mfma_f32_16x16x32_bf16 v[28:31], v[116:119], v[136:139], v[28:31]
  ds_read_b64_tr_b16 v[58:59], v201 offset:3328
  v_mfma_f32_16x16x32_bf16 v[28:31], v[112:115], v[140:143], v[28:31]
  ds_read_b64 v[92:93], v206 offset:7168
  v_mfma_f32_16x16x32_bf16 v[28:31], v[108:111], v[144:147], v[28:31]
  ds_read_b64 v[94:95], v207 offset:7168
  v_mfma_f32_16x16x32_bf16 v[28:31], v[104:107], v[148:151], v[28:31]
  ds_read_b64_tr_b16 v[60:61], v201 offset:3872
  v_mfma_f32_16x16x32_bf16 v[28:31], v[100:103], v[152:155], v[28:31]
  ds_read_b64_tr_b16 v[62:63], v201 offset:3840
  v_mfma_f32_16x16x32_bf16 v[28:31], v[96:99], v[156:159], v[28:31]
  s_waitcnt lgkmcnt(15)
  v_mfma_f32_16x16x32_bf16 v[0:3], v[32:35], v[64:67], v[0:3]
  ds_read_b64 v[128:129], v204 offset:512
  v_mfma_f32_16x16x32_bf16 v[4:7], v[36:39], v[64:67], v[4:7]
  ds_read_b64 v[130:131], v205 offset:512
  v_mfma_f32_16x16x32_bf16 v[4:7], v[32:35], v[68:71], v[4:7]
  ds_read_b64_tr_b16 v[96:97], v201 offset:32
  v_mfma_f32_16x16x32_bf16 v[8:11], v[40:43], v[64:67], v[8:11]
  ds_read_b64_tr_b16 v[98:99], v201 offset:0
  v_mfma_f32_16x16x32_bf16 v[8:11], v[36:39], v[68:71], v[8:11]
  ds_read_b64 v[132:133], v208 offset:1536
  v_mfma_f32_16x16x32_bf16 v[8:11], v[32:35], v[72:75], v[8:11]
  ds_read_b64 v[134:135], v209 offset:1536
  v_mfma_f32_16x16x32_bf16 v[12:15], v[44:47], v[64:67], v[12:15]
  ds_read_b64_tr_b16 v[100:101], v201 offset:544
  v_mfma_f32_16x16x32_bf16 v[12:15], v[40:43], v[68:71], v[12:15]
  ds_read_b64_tr_b16 v[102:103], v201 offset:512
  v_mfma_f32_16x16x32_bf16 v[12:15], v[36:39], v[72:75], v[12:15]
  v_mfma_f32_16x16x32_bf16 v[12:15], v[32:35], v[76:79], v[12:15]
  ds_read_b64 v[136:137], v204 offset:2560
  s_waitcnt lgkmcnt(15)
  v_mfma_f32_16x16x32_bf16 v[16:19], v[48:51], v[64:67], v[16:19]
  ds_read_b64 v[138:139], v205 offset:2560
  v_mfma_f32_16x16x32_bf16 v[16:19], v[44:47], v[68:71], v[16:19]
  ds_read_b64_tr_b16 v[104:105], v201 offset:1056
  v_mfma_f32_16x16x32_bf16 v[16:19], v[40:43], v[72:75], v[16:19]
  ds_read_b64_tr_b16 v[106:107], v201 offset:1024
  v_mfma_f32_16x16x32_bf16 v[16:19], v[36:39], v[76:79], v[16:19]
  ds_read_b64 v[140:141], v208 offset:3584
  v_mfma_f32_16x16x32_bf16 v[16:19], v[32:35], v[80:83], v[16:19]
  ds_read_b64 v[142:143], v209 offset:3584
  v_mfma_f32_16x16x32_bf16 v[20:23], v[52:55], v[64:67], v[20:23]
  ds_read_b64_tr_b16 v[108:109], v201 offset:1568
  v_mfma_f32_16x16x32_bf16 v[20:23], v[48:51], v[68:71], v[20:23]
  ds_read_b64_tr_b16 v[110:111], v201 offset:1536
  v_mfma_f32_16x16x32_bf16 v[20:23], v[44:47], v[72:75], v[20:23]
  v_mfma_f32_16x16x32_bf16 v[20:23], v[40:43], v[76:79], v[20:23]
  ds_read_b64 v[144:145], v204 offset:4608
  v_mfma_f32_16x16x32_bf16 v[20:23], v[36:39], v[80:83], v[20:23]
  ds_read_b64 v[146:147], v205 offset:4608
  v_mfma_f32_16x16x32_bf16 v[20:23], v[32:35], v[84:87], v[20:23]
  ds_read_b64_tr_b16 v[112:113], v201 offset:2080
  s_waitcnt lgkmcnt(15)
  v_mfma_f32_16x16x32_bf16 v[24:27], v[56:59], v[64:67], v[24:27]
  ds_read_b64_tr_b16 v[114:115], v201 offset:2048
  v_mfma_f32_16x16x32_bf16 v[24:27], v[52:55], v[68:71], v[24:27]
  ds_read_b64 v[148:149], v208 offset:5632
  v_mfma_f32_16x16x32_bf16 v[24:27], v[48:51], v[72:75], v[24:27]
  ds_read_b64 v[150:151], v209 offset:5632
  v_mfma_f32_16x16x32_bf16 v[24:27], v[44:47], v[76:79], v[24:27]
  ds_read_b64_tr_b16 v[116:117], v201 offset:2592
  v_mfma_f32_16x16x32_bf16 v[24:27], v[40:43], v[80:83], v[24:27]
  ds_read_b64_tr_b16 v[118:119], v201 offset:2560
  v_mfma_f32_16x16x32_bf16 v[24:27], v[36:39], v[84:87], v[24:27]
  v_mfma_f32_16x16x32_bf16 v[24:27], v[32:35], v[88:91], v[24:27]
  ds_read_b64 v[152:153], v204 offset:6656
  v_mfma_f32_16x16x32_bf16 v[28:31], v[60:63], v[64:67], v[28:31]
  ds_read_b64 v[154:155], v205 offset:6656
  v_mfma_f32_16x16x32_bf16 v[28:31], v[56:59], v[68:71], v[28:31]
  ds_read_b64_tr_b16 v[120:121], v201 offset:3104
  v_mfma_f32_16x16x32_bf16 v[28:31], v[52:55], v[72:75], v[28:31]
  ds_read_b64_tr_b16 v[122:123], v201 offset:3072
  v_mfma_f32_16x16x32_bf16 v[28:31], v[48:51], v[76:79], v[28:31]
  ds_read_b64 v[156:157], v208 offset:7680
  v_mfma_f32_16x16x32_bf16 v[28:31], v[44:47], v[80:83], v[28:31]
  ds_read_b64 v[158:159], v209 offset:7680
  v_mfma_f32_16x16x32_bf16 v[28:31], v[40:43], v[84:87], v[28:31]
  ds_read_b64_tr_b16 v[124:125], v201 offset:3616
  v_mfma_f32_16x16x32_bf16 v[28:31], v[36:39], v[88:91], v[28:31]
  ds_read_b64_tr_b16 v[126:127], v201 offset:3584
  v_mfma_f32_16x16x32_bf16 v[28:31], v[32:35], v[92:95], v[28:31]
  s_bitcmp1_b32 s61, 0
  s_cbranch_scc1 L_C_p1
  s_waitcnt lgkmcnt(12)
  v_mfma_f32_16x16x32_bf16 v[16:19], v[112:115], v[128:131], v[16:19]
  v_mfma_f32_16x16x32_bf16 v[16:19], v[108:111], v[132:135], v[16:19]
  v_mfma_f32_16x16x32_bf16 v[16:19], v[104:107], v[136:139], v[16:19]
  v_mfma_f32_16x16x32_bf16 v[16:19], v[100:103], v[140:143], v[16:19]
  v_mfma_f32_16x16x32_bf16 v[16:19], v[96:99], v[144:147], v[16:19]
  s_waitcnt lgkmcnt(8)
  v_mfma_f32_16x16x32_bf16 v[20:23], v[116:119], v[128:131], v[20:23]
  v_mfma_f32_16x16x32_bf16 v[20:23], v[112:115], v[132:135], v[20:23]
  v_mfma_f32_16x16x32_bf16 v[20:23], v[108:111], v[136:139], v[20:23]
  v_mfma_f32_16x16x32_bf16 v[20:23], v[104:107], v[140:143], v[20:23]
  v_mfma_f32_16x16x32_bf16 v[20:23], v[100:103], v[144:147], v[20:23]
  v_mfma_f32_16x16x32_bf16 v[20:23], v[96:99], v[148:151], v[20:23]
  s_waitcnt lgkmcnt(4)
  v_mfma_f32_16x16x32_bf16 v[24:27], v[120:123], v[128:131], v[24:27]
  v_mfma_f32_16x16x32_bf16 v[24:27], v[116:119], v[132:135], v[24:27]
  ds_write_b128 v213, v[16:19] offset:0
  v_mfma_f32_16x16x32_bf16 v[24:27], v[112:115], v[136:139], v[24:27]
  v_mfma_f32_16x16x32_bf16 v[24:27], v[108:111], v[140:143], v[24:27]
  v_mfma_f32_16x16x32_bf16 v[24:27], v[104:107], v[144:147], v[24:27]
  v_mfma_f32_16x16x32_bf16 v[24:27], v[100:103], v[148:151], v[24:27]
  v_mfma_f32_16x16x32_bf16 v[24:27], v[96:99], v[152:155], v[24:27]
  s_waitcnt lgkmcnt(1)
  v_mfma_f32_16x16x32_bf16 v[28:31], v[124:127], v[128:131], v[28:31]
  ds_write_b128 v213, v[20:23] offset:1024
  v_mfma_f32_16x16x32_bf16 v[28:31], v[120:123], v[132:135], v[28:31]
  v_mfma_f32_16x16x32_bf16 v[28:31], v[116:119], v[136:139], v[28:31]
  v_mfma_f32_16x16x32_bf16 v[28:31], v[112:115], v[140:143], v[28:31]
  v_mfma_f32_16x16x32_bf16 v[28:31], v[108:111], v[144:147], v[28:31]
  v_mfma_f32_16x16x32_bf16 v[28:31], v[104:107], v[148:151], v[28:31]
  v_mfma_f32_16x16x32_bf16 v[28:31], v[100:103], v[152:155], v[28:31]
  v_mfma_f32_16x16x32_bf16 v[28:31], v[96:99], v[156:159], v[28:31]
  ds_write_b128 v213, v[24:27] offset:2048
  v_mfma_f32_16x16x32_bf16 v[0:3], v[96:99], v[128:131], v[0:3]
  v_mfma_f32_16x16x32_bf16 v[4:7], v[100:103], v[128:131], v[4:7]
  v_mfma_f32_16x16x32_bf16 v[4:7], v[96:99], v[132:135], v[4:7]
  v_mfma_f32_16x16x32_bf16 v[8:11], v[104:107], v[128:131], v[8:11]
  s_nop 2
  ds_write_b128 v213, v[28:31] offset:3072
  ds_write_b32 v184, v253
  v_mfma_f32_16x16x32_bf16 v[8:11], v[100:103], v[132:135], v[8:11]
  v_fma_f32 v160, v160, s68, v0
  v_fma_f32 v161, v161, s68, v1
  v_mfma_f32_16x16x32_bf16 v[8:11], v[96:99], v[136:139], v[8:11]
  ds_read_b32 v186, v185
  ds_read_b128 v[32:35], v214 offset:0
  v_fma_f32 v162, v162, s68, v2
  v_fma_f32 v163, v163, s68, v3
  v_mfma_f32_16x16x32_bf16 v[12:15], v[108:111], v[128:131], v[12:15]
  ds_read_b128 v[36:39], v214 offset:1024
  ds_read_b128 v[40:43], v214 offset:2048
  v_fma_f32 v164, v164, s68, v4
  v_fma_f32 v165, v165, s68, v5
  v_mfma_f32_16x16x32_bf16 v[12:15], v[104:107], v[132:135], v[12:15]
  ds_read_b128 v[44:47], v214 offset:3072
  v_fma_f32 v166, v166, s68, v6
  v_fma_f32 v167, v167, s68, v7
  v_mfma_f32_16x16x32_bf16 v[12:15], v[100:103], v[136:139], v[12:15]
  v_mfma_f32_16x16x32_bf16 v[12:15], v[96:99], v[140:143], v[12:15]
  v_fma_f32 v168, v168, s68, v8
  v_fma_f32 v169, v169, s68, v9
  v_fma_f32 v170, v170, s68, v10
  v_fma_f32 v171, v171, s68, v11
  s_nop 3
  v_fma_f32 v172, v172, s68, v12
  v_fma_f32 v173, v173, s68, v13
  v_fma_f32 v174, v174, s68, v14
  v_fma_f32 v175, v175, s68, v15
  s_waitcnt lgkmcnt(4)
  v_readfirstlane_b32 s63, v186
  s_nop 0
  s_cmp_lg_u32 s63, 0
  s_cbranch_scc1 L_x0_ok
L_x0:
  ds_read_b32 v186, v185
  ds_read_b128 v[32:35], v214 offset:0
  ds_read_b128 v[36:39], v214 offset:1024
  ds_read_b128 v[40:43], v214 offset:2048
  ds_read_b128 v[44:47], v214 offset:3072
  s_add_u32 s72, s72, 1
  s_cmp_ge_u32 s72, 200000
  s_waitcnt lgkmcnt(0)
  s_cbranch_scc1 L_x0_ok
  v_readfirstlane_b32 s63, v186
  s_nop 0
  s_cmp_eq_u32 s63, 0
  s_cbranch_scc1 L_x0
L_x0_ok:
  s_waitcnt lgkmcnt(3)
  v_add_f32 v160, v160, v35
  v_add_f32 v161, v161, v32
  v_add_f32 v162, v162, v33
  v_add_f32 v163, v163, v34
  s_waitcnt lgkmcnt(2)
  v_add_f32 v164, v164, v39
  v_add_f32 v165, v165, v36
  v_add_f32 v166, v166, v37
  v_add_f32 v167, v167, v38
  s_waitcnt lgkmcnt(1)
  v_add_f32 v168, v168, v43
  v_add_f32 v169, v169, v40
  v_add_f32 v170, v170, v41
  v_add_f32 v171, v171, v42
  s_waitcnt lgkmcnt(0)
  v_add_f32 v172, v172, v47
  v_add_f32 v173, v173, v44
  v_add_f32 v174, v174, v45
  v_add_f32 v175, v175, v46
  s_branch L_C_pj
L_C_p1:
  v_mfma_f32_16x16x32_bf16 v[0:3], v[96:99], v[128:131], v[0:3]
  s_waitcnt lgkmcnt(15)
  v_mfma_f32_16x16x32_bf16 v[4:7], v[100:103], v[128:131], v[4:7]
  v_mfma_f32_16x16x32_bf16 v[4:7], v[96:99], v[132:135], v[4:7]
  v_mfma_f32_16x16x32_bf16 v[8:11], v[104:107], v[128:131], v[8:11]
  v_mfma_f32_16x16x32_bf16 v[8:11], v[100:103], v[132:135], v[8:11]
  v_mfma_f32_16x16x32_bf16 v[8:11], v[96:99], v[136:139], v[8:11]
  v_mfma_f32_16x16x32_bf16 v[12:15], v[108:111], v[128:131], v[12:15]
  v_mfma_f32_16x16x32_bf16 v[12:15], v[104:107], v[132:135], v[12:15]
  v_mfma_f32_16x16x32_bf16 v[12:15], v[100:103], v[136:139], v[12:15]
  v_mfma_f32_16x16x32_bf16 v[12:15], v[96:99], v[140:143], v[12:15]
  s_waitcnt lgkmcnt(12)
  v_mfma_f32_16x16x32_bf16 v[16:19], v[112:115], v[128:131], v[16:19]
  v_mfma_f32_16x16x32_bf16 v[16:19], v[108:111], v[132:135], v[16:19]
  v_mfma_f32_16x16x32_bf16 v[16:19], v[104:107], v[136:139], v[16:19]
  v_cndmask_b32 v64, v3, v254, vcc
  v_cndmask_b32 v65, v7, v3, vcc
  v_mfma_f32_16x16x32_bf16 v[16:19], v[100:103], v[140:143], v[16:19]
  v_cndmask_b32 v66, v11, v7, vcc
  v_mov_b32 v80, v15
  v_mfma_f32_16x16x32_bf16 v[16:19], v[96:99], v[144:147], v[16:19]
  v_cndmask_b32 v67, v15, v11, vcc
  ds_bpermute_b32 v3, v212, v64
  s_waitcnt lgkmcnt(9)
  v_mfma_f32_16x16x32_bf16 v[20:23], v[116:119], v[128:131], v[20:23]
  ds_bpermute_b32 v7, v212, v65
  ds_bpermute_b32 v11, v212, v66
  v_mfma_f32_16x16x32_bf16 v[20:23], v[112:115], v[132:135], v[20:23]
  ds_bpermute_b32 v15, v212, v67
  v_mfma_f32_16x16x32_bf16 v[20:23], v[108:111], v[136:139], v[20:23]
  v_mfma_f32_16x16x32_bf16 v[20:23], v[104:107], v[140:143], v[20:23]
  v_mfma_f32_16x16x32_bf16 v[20:23], v[100:103], v[144:147], v[20:23]
  v_mfma_f32_16x16x32_bf16 v[20:23], v[96:99], v[148:151], v[20:23]
  s_waitcnt lgkmcnt(8)
  v_mfma_f32_16x16x32_bf16 v[24:27], v[120:123], v[128:131], v[24:27]
  v_mfma_f32_16x16x32_bf16 v[24:27], v[116:119], v[132:135], v[24:27]
  s_waitcnt lgkmcnt(3)
  ds_write_b128 v213, v[0:3] offset:0
  v_cndmask_b32 v68, v19, v80, vcc
  ds_bpermute_b32 v76, v212, v68
  v_mfma_f32_16x16x32_bf16 v[24:27], v[112:115], v[136:139], v[24:27]
  s_waitcnt lgkmcnt(4)
  ds_write_b128 v213, v[4:7] offset:1024
  v_mfma_f32_16x16x32_bf16 v[24:27], v[108:111], v[140:143], v[24:27]
  s_waitcnt lgkmcnt(4)
  ds_write_b128 v213, v[8:11] offset:2048
  v_mfma_f32_16x16x32_bf16 v[24:27], v[104:107], v[144:147], v[24:27]
  s_waitcnt lgkmcnt(4)
  ds_write_b128 v213, v[12:15] offset:3072
  v_mfma_f32_16x16x32_bf16 v[24:27], v[100:103], v[148:151], v[24:27]
  ds_write_b32 v184, v253
  v_mfma_f32_16x16x32_bf16 v[24:27], v[96:99], v[152:155], v[24:27]
  v_cndmask_b32 v69, v23, v19, vcc
  ds_bpermute_b32 v77, v212, v69
  v_mfma_f32_16x16x32_bf16 v[28:31], v[124:127], v[128:131], v[28:31]
  v_fma_f32 v161, v161, s68, v16
  v_fma_f32 v162, v162, s68, v17
  v_mfma_f32_16x16x32_bf16 v[28:31], v[120:123], v[132:135], v[28:31]
  v_fma_f32 v163, v163, s68, v18
  s_waitcnt lgkmcnt(5)
  v_fma_f32 v160, v160, s68, v76
  v_mfma_f32_16x16x32_bf16 v[28:31], v[116:119], v[136:139], v[28:31]
  v_mfma_f32_16x16x32_bf16 v[28:31], v[112:115], v[140:143], v[28:31]
  v_mfma_f32_16x16x32_bf16 v[28:31], v[108:111], v[144:147], v[28:31]
  v_mfma_f32_16x16x32_bf16 v[28:31], v[104:107], v[148:151], v[28:31]
  v_cndmask_b32 v70, v27, v23, vcc
  ds_bpermute_b32 v78, v212, v70
  v_mfma_f32_16x16x32_bf16 v[28:31], v[100:103], v[152:155], v[28:31]
  v_fma_f32 v165, v165, s68, v20
  v_fma_f32 v166, v166, s68, v21
  v_mfma_f32_16x16x32_bf16 v[28:31], v[96:99], v[156:159], v[28:31]
  v_fma_f32 v167, v167, s68, v22
  s_waitcnt lgkmcnt(1)
  v_fma_f32 v164, v164, s68, v77
  ds_read_b32 v186, v185
  ds_read_b128 v[32:35], v214 offset:0
  ds_read_b128 v[36:39], v214 offset:1024
  ds_read_b128 v[40:43], v214 offset:2048
  ds_read_b128 v[44:47], v214 offset:3072
  v_fma_f32 v169, v169, s68, v24
  v_fma_f32 v170, v170, s68, v25
  v_fma_f32 v171, v171, s68, v26
  s_waitcnt lgkmcnt(5)
  v_fma_f32 v168, v168, s68, v78
  v_cndmask_b32 v71, v31, v27, vcc
  ds_bpermute_b32 v79, v212, v71
  v_fma_f32 v173, v173, s68, v28
  v_fma_f32 v174, v174, s68, v29
  v_fma_f32 v175, v175, s68, v30
  s_waitcnt lgkmcnt(5)
  v_readfirstlane_b32 s63, v186
  s_nop 0
  s_cmp_lg_u32 s63, 0
  s_cbranch_scc1 L_x1_ok
L_x1:
  ds_read_b32 v186, v185
  ds_read_b128 v[32:35], v214 offset:0
  ds_read_b128 v[36:39], v214 offset:1024
  ds_read_b128 v[40:43], v214 offset:2048
  ds_read_b128 v[44:47], v214 offset:3072
  s_add_u32 s72, s72, 1
  s_cmp_ge_u32 s72, 200000
  s_waitcnt lgkmcnt(0)
  s_cbranch_scc1 L_x1_ok
  v_readfirstlane_b32 s63, v186
  s_nop 0
  s_cmp_eq_u32 s63, 0
  s_cbranch_scc1 L_x1
L_x1_ok:
  s_waitcnt lgkmcnt(4)
  v_add_f32 v160, v160, v32
  v_add_f32 v161, v161, v33
  v_add_f32 v162, v162, v34
  v_add_f32 v163, v163, v35
  s_waitcnt lgkmcnt(3)
  v_add_f32 v164, v164, v36
  v_add_f32 v165, v165, v37
  v_add_f32 v166, v166, v38
  v_add_f32 v167, v167, v39
  s_waitcnt lgkmcnt(2)
  v_add_f32 v168, v168, v40
  v_add_f32 v169, v169, v41
  v_add_f32 v170, v170, v42
  v_add_f32 v171, v171, v43
  s_waitcnt lgkmcnt(0)
  v_fma_f32 v172, v172, s68, v79
  v_add_f32 v173, v173, v45
  v_add_f32 v174, v174, v46
  v_add_f32 v175, v175, v47
  v_add_f32 v172, v172, v44
L_C_pj:
  s_waitcnt lgkmcnt(0)
  v_cvt_pk_bf16_f32 v48, v160, v161
  v_cvt_pk_bf16_f32 v49, v162, v163
  v_cvt_pk_bf16_f32 v50, v164, v165
  v_cvt_pk_bf16_f32 v51, v166, v167
  v_cvt_pk_bf16_f32 v52, v168, v169
  v_cvt_pk_bf16_f32 v53, v170, v171
  v_cvt_pk_bf16_f32 v54, v172, v173
  v_cvt_pk_bf16_f32 v55, v174, v175
  v_permlane16_swap_b32 v48, v50
  v_permlane16_swap_b32 v49, v51
  buffer_store_dwordx4 v[48:51], v211, s[48:51], s62 offen offset:0 sc1
  v_permlane16_swap_b32 v52, v54
  v_permlane16_swap_b32 v53, v55
  buffer_store_dwordx4 v[52:55], v211, s[48:51], s62 offen offset:1024 sc1
  s_and_b32 s64, s61, 1
  s_lshl1_add_u32 s63, s54, s64
  s_lshr_b32 s64, s55, 4
  s_lshl1_add_u32 s63, s63, s64
  s_lshr_b32 s64, s61, 1
  s_lshl1_add_u32 s63, s63, s64
  s_add_u32 s63, s63, 64
  s_lshl_b32 s3, s63, 7
  s_lshr_b32 s63, s79, 4
  s_lshl1_add_u32 s63, s31, s63
  s_lshl1_add_u32 s63, s63, s64
  s_lshl_b32 s63, s63, 8
  s_add_u32 s8, s63, 8192
  s_add_u32 s9, s63, 8320
  ds_read_b128 v[188:191], v187 offset:0
  ds_read_b128 v[192:195], v187 offset:512
  s_waitcnt vmcnt(0)
  s_mov_b32 s17, 1
  s_atomic_add s17, s[48:49], s3
  s_mov_b32 s42, 2097152
  s_mov_b32 s43, 0x20000
  v_lshrrev_b32 v1, 5, v255
  v_and_b32 v6, 3, v247
  v_bfe_u32 v7, v247, 2, 1
  v_and_b32 v17, 7, v247
  s_and_b32 s63, s61, 1
  s_lshl_b32 s63, s63, 3
  v_and_b32 v16, 3, v255
  v_lshlrev_b32 v18, 4, v16
  v_lshl_add_u32 v248, v247, 10, v18
  s_lshr_b32 s64, s61, 1
  s_mul_i32 s64, s64, 2304
  s_lshl4_add_u32 s65, s63, s64
  v_lshrrev_b32 v18, 1, v16
  v_lshl_add_u32 v18, v1, 2, v18
  v_mul_u32_u24 v18, 1152, v18
  v_mul_u32_u24 v19, 272, v6
  v_add3_u32 v18, v18, v19, s65
  v_lshl_add_u32 v18, v7, 6, v18
  v_and_b32 v19, 1, v16
  v_lshl_add_u32 v249, v19, 5, v18
  v_add_u32 v250, 0x10000, v249
  v_xor_b32 v18, v1, v16
  v_lshlrev_b32 v18, 4, v18
  v_lshrrev_b32 v19, 2, v255
  v_mul_u32_u24 v19, 4224, v19
  v_add_u32 v197, v19, v18
  v_xor_b32 v198, 32, v197
  v_add_u32 v198, 66560, v198
  v_lshl_add_u32 v18, v16, 9, v18
  v_lshl_add_u32 v18, v17, 1, v18
  v_add_u32 v251, s29, v18
  v_xor_b32 v241, 32, v251
  v_lshlrev_b32 v64, 16, v216
  v_and_b32 v65, 0xffff0000, v216
  v_lshlrev_b32 v66, 16, v217
  v_and_b32 v67, 0xffff0000, v217
  v_lshlrev_b32 v68, 16, v218
  v_and_b32 v69, 0xffff0000, v218
  v_lshlrev_b32 v70, 16, v219
  v_and_b32 v71, 0xffff0000, v219
  v_lshlrev_b32 v72, 16, v220
  v_and_b32 v73, 0xffff0000, v220
  v_lshlrev_b32 v74, 16, v221
  v_and_b32 v75, 0xffff0000, v221
  v_lshlrev_b32 v76, 16, v222
  v_and_b32 v77, 0xffff0000, v222
  v_lshlrev_b32 v78, 16, v223
  v_and_b32 v79, 0xffff0000, v223
  v_lshlrev_b32 v96, 16, v228
  v_and_b32 v97, 0xffff0000, v228
  v_lshlrev_b32 v98, 16, v229
  v_and_b32 v99, 0xffff0000, v229
  v_lshlrev_b32 v100, 16, v230
  v_and_b32 v101, 0xffff0000, v230
  v_lshlrev_b32 v102, 16, v231
  v_and_b32 v103, 0xffff0000, v231
  s_waitcnt lgkmcnt(0)
  v_lshlrev_b32 v188, 16, v188
  v_mul_f32 v190, 0xbede652a, v190
  v_lshlrev_b32 v192, 16, v192
  v_mul_f32 v194, 0xbede652a, v194
  v_add_f32 v80, v64, v188
  v_mov_b32 v104, 0
  v_add_f32 v81, v65, v188
  v_mov_b32 v105, 0
  v_add_f32 v82, v66, v188
  v_mov_b32 v106, 0
  v_add_f32 v83, v67, v188
  v_mov_b32 v107, 0
  v_add_f32 v84, v68, v188
  v_mov_b32 v108, 0
  v_add_f32 v85, v69, v188
  v_mov_b32 v109, 0
  v_add_f32 v86, v70, v188
  v_mov_b32 v110, 0
  v_add_f32 v87, v71, v188
  v_mov_b32 v111, 0
  v_add_f32 v88, v72, v192
  v_mov_b32 v112, 0
  v_add_f32 v89, v73, v192
  v_mov_b32 v113, 0
  v_add_f32 v90, v74, v192
  v_mov_b32 v114, 0
  v_add_f32 v91, v75, v192
  v_mov_b32 v115, 0
  v_add_f32 v92, v76, v192
  v_mov_b32 v116, 0
  v_add_f32 v93, v77, v192
  v_mov_b32 v117, 0
  v_add_f32 v94, v78, v192
  v_mov_b32 v118, 0
  v_add_f32 v95, v79, v192
  v_mov_b32 v119, 0
  v_mul_f32 v80, v80, v190
  v_mul_f32 v81, v81, v190
  v_mul_f32 v82, v82, v190
  v_mul_f32 v83, v83, v190
  v_mul_f32 v84, v84, v190
  v_mul_f32 v85, v85, v190
  v_mul_f32 v86, v86, v190
  v_mul_f32 v87, v87, v190
  v_mul_f32 v88, v88, v194
  v_mul_f32 v89, v89, v194
  v_mul_f32 v90, v90, v194
  v_mul_f32 v91, v91, v194
  v_mul_f32 v92, v92, v194
  v_mul_f32 v93, v93, v194
  v_mul_f32 v94, v94, v194
  v_mul_f32 v95, v95, v194
  s_add_u32 s71, s30, 32768
  v_mov_b32 v120, 0xbfb8aa3b
  v_mov_b32 v121, 0xbfb8aa3b
  v_mov_b32 v122, 1.0
  v_mov_b32 v123, 1.0
  s_lshr_b32 s64, s61, 1
  s_lshl1_add_u32 s63, s31, s64
  s_mul_i32 s63, s63, 135168
  s_and_b32 s65, s61, 1
  s_lshl1_add_u32 s64, s79, s65
  s_lshl_b32 s64, s64, 6
  s_add_u32 s63, s63, s64
  s_add_u32 s63, s63, 2621440
  s_mov_b32 m0, s29
  s_mov_b32 s72, 0
L_yw:
  s_sleep 2
  ds_read_b32 v186, v184 offset:16
  s_add_u32 s72, s72, 1
  s_cmp_ge_u32 s72, 400000
  s_cbranch_scc1 L_yw_ok
  s_waitcnt lgkmcnt(0)
  v_readfirstlane_b32 s65, v186
  s_nop 0
  s_cmp_eq_u32 s65, 0
  s_cbranch_scc1 L_yw
L_yw_ok:
  s_load_dword s12, s[48:49], s8
  s_load_dword s13, s[48:49], s9
  s_mov_b32 s72, 0
L_poll2:
  s_waitcnt lgkmcnt(0)
  s_cmp_lt_u32 s12, 16
  s_cbranch_scc1 L_poll2_re
  s_cmp_ge_u32 s13, 16
  s_cbranch_scc1 L_poll2_ok
L_poll2_re:
  s_add_u32 s72, s72, 1
  s_cmp_ge_u32 s72, 50000
  s_cbranch_scc1 L_poll2_ok
  s_sleep 4
  buffer_load_dword v24, v254, s[48:51], s8 offen sc1
  buffer_load_dword v25, v254, s[48:51], s9 offen sc1
  s_waitcnt vmcnt(0)
  v_readfirstlane_b32 s12, v24
  v_readfirstlane_b32 s13, v25
  s_branch L_poll2
L_poll2_ok:
  buffer_load_dwordx4 v197, s[48:51], s63 offen sc1 lds
  buffer_load_dwordx4 v198, s[48:51], s63 offen offset:1024 sc1 lds
  s_barrier
  ds_read_b128 v[0:3], v249 offset:0
  ds_read_b128 v[4:7], v249 offset:16
  ds_read_b128 v[8:11], v249 offset:16384
  ds_read_b128 v[12:15], v249 offset:16400
  ds_read_b128 v[16:19], v249 offset:32768
  ds_read_b128 v[20:23], v249 offset:32784
  ds_read_b128 v[24:27], v249 offset:49152
  ds_read_b128 v[28:31], v249 offset:49168
  s_waitcnt lgkmcnt(7)
  v_add_f32 v0, v0, v96
  v_add_f32 v1, v1, v97
  v_add_f32 v2, v2, v98
  v_add_f32 v3, v3, v99
  s_waitcnt lgkmcnt(6)
L_warm_a1:
  s_cbranch_execz L_warm_ret
  s_nop 0
  v_add_f32 v4, v4, v100
  v_add_f32 v5, v5, v101
  v_add_f32 v6, v6, v102
  v_add_f32 v7, v7, v103
  s_waitcnt lgkmcnt(5)
  v_add_f32 v0, v0, v8
  v_add_f32 v1, v1, v9
  v_add_f32 v2, v2, v10
  v_add_f32 v3, v3, v11
  s_waitcnt lgkmcnt(4)
  v_add_f32 v4, v4, v12
  v_add_f32 v5, v5, v13
  v_add_f32 v6, v6, v14
  v_add_f32 v7, v7, v15
  s_waitcnt lgkmcnt(3)
  v_add_f32 v0, v0, v16
  v_add_f32 v1, v1, v17
  v_add_f32 v2, v2, v18
  v_add_f32 v3, v3, v19
  s_waitcnt lgkmcnt(2)
  v_add_f32 v4, v4, v20
  v_add_f32 v5, v5, v21
  v_add_f32 v6, v6, v22
  v_add_f32 v7, v7, v23
  s_waitcnt lgkmcnt(1)
  v_add_f32 v0, v0, v24
  v_add_f32 v1, v1, v25
  v_add_f32 v2, v2, v26
  v_add_f32 v3, v3, v27
  s_waitcnt lgkmcnt(0)
  v_add_f32 v4, v4, v28
  v_add_f32 v5, v5, v29
  v_add_f32 v6, v6, v30
  v_add_f32 v7, v7, v31
  v_mul_f32 v124, v0, v120
  v_mul_f32 v125, v1, v120
  v_mul_f32 v126, v2, v120
  v_mul_f32 v127, v3, v120
  v_mul_f32 v128, v4, v120
  v_mul_f32 v129, v5, v120
  v_mul_f32 v130, v6, v120
  v_mul_f32 v131, v7, v120
  v_exp_f32 v124, v124
  v_exp_f32 v125, v125
  v_exp_f32 v126, v126
  v_exp_f32 v127, v127
  v_exp_f32 v128, v128
  v_exp_f32 v129, v129
  v_exp_f32 v130, v130
  v_exp_f32 v131, v131
  v_add_f32 v124, 1.0, v124
  v_add_f32 v125, 1.0, v125
  v_add_f32 v126, 1.0, v126
  v_add_f32 v127, 1.0, v127
  v_add_f32 v128, 1.0, v128
  v_add_f32 v129, 1.0, v129
  v_add_f32 v130, 1.0, v130
  v_add_f32 v131, 1.0, v131
  v_rcp_f32 v124, v124
  v_rcp_f32 v125, v125
  v_rcp_f32 v126, v126
  v_rcp_f32 v127, v127
  v_rcp_f32 v128, v128
  v_rcp_f32 v129, v129
  v_rcp_f32 v130, v130
  v_rcp_f32 v131, v131
  v_mul_f32 v0, v0, v80
  v_mul_f32 v1, v1, v81
  v_mul_f32 v2, v2, v82
  v_mul_f32 v3, v3, v83
  v_mul_f32 v4, v4, v84
  v_mul_f32 v5, v5, v85
  v_mul_f32 v6, v6, v86
  v_mul_f32 v7, v7, v87
  v_mul_f32 v124, v124, v0
  v_mul_f32 v125, v125, v1
  v_mul_f32 v126, v126, v2
  v_mul_f32 v127, v127, v3
  v_mul_f32 v128, v128, v4
  v_mul_f32 v129, v129, v5
  v_mul_f32 v130, v130, v6
  v_mul_f32 v131, v131, v7
  s_waitcnt vmcnt(0)
  ds_read_u16_d16_hi v104, v251 offset:0
  ds_read_u16_d16_hi v105, v251 offset:64
  ds_read_u16_d16_hi v106, v251 offset:128
  ds_read_u16_d16_hi v107, v251 offset:192
  ds_read_u16_d16_hi v108, v251 offset:256
  ds_read_u16_d16_hi v109, v251 offset:320
  ds_read_u16_d16_hi v110, v251 offset:384
  ds_read_u16_d16_hi v111, v251 offset:448
  ds_read_u16_d16_hi v112, v241 offset:0
  ds_read_u16_d16_hi v113, v241 offset:64
  ds_read_u16_d16_hi v114, v241 offset:128
  ds_read_u16_d16_hi v115, v241 offset:192
  ds_read_u16_d16_hi v116, v241 offset:256
  ds_read_u16_d16_hi v117, v241 offset:320
  ds_read_u16_d16_hi v118, v241 offset:384
  ds_read_u16_d16_hi v119, v241 offset:448
  s_barrier
  ds_read_b128 v[32:35], v250 offset:0
  ds_read_b128 v[36:39], v250 offset:16
  ds_read_b128 v[40:43], v250 offset:12288
  ds_read_b128 v[44:47], v250 offset:12304
  ds_read_b128 v[48:51], v250 offset:32768
  ds_read_b128 v[52:55], v250 offset:32784
  ds_read_b128 v[56:59], v250 offset:45056
  ds_read_b128 v[60:63], v250 offset:45072
  s_waitcnt lgkmcnt(15)
  v_pk_fma_f32 v[124:125], v[124:125], v[104:105], v[64:65]
  v_pk_fma_f32 v[126:127], v[126:127], v[106:107], v[66:67]
  v_pk_fma_f32 v[128:129], v[128:129], v[108:109], v[68:69]
  v_pk_fma_f32 v[130:131], v[130:131], v[110:111], v[70:71]
  v_cvt_pk_bf16_f32 v132, v124, v125
  v_cvt_pk_bf16_f32 v133, v126, v127
  v_cvt_pk_bf16_f32 v134, v128, v129
  v_cvt_pk_bf16_f32 v135, v130, v131
  buffer_store_dwordx4 v[132:135], v248, s[40:43], s30 offen sc1
  s_waitcnt lgkmcnt(14)
  v_pk_mul_f32 v[88:89], v[88:89], v[112:113]
  s_waitcnt lgkmcnt(12)
  v_pk_mul_f32 v[90:91], v[90:91], v[114:115]
  s_waitcnt lgkmcnt(10)
  v_pk_mul_f32 v[92:93], v[92:93], v[116:117]
  s_waitcnt lgkmcnt(8)
  v_pk_mul_f32 v[94:95], v[94:95], v[118:119]
  s_waitcnt lgkmcnt(7)
  v_pk_add_f32 v[32:33], v[32:33], v[96:97]
  v_pk_add_f32 v[34:35], v[34:35], v[98:99]
  s_waitcnt lgkmcnt(6)
  v_pk_add_f32 v[36:37], v[36:37], v[100:101]
  v_pk_add_f32 v[38:39], v[38:39], v[102:103]
  s_waitcnt lgkmcnt(5)
  v_pk_add_f32 v[32:33], v[32:33], v[40:41]
  v_pk_add_f32 v[34:35], v[34:35], v[42:43]
  s_waitcnt lgkmcnt(4)
  v_pk_add_f32 v[36:37], v[36:37], v[44:45]
  v_pk_add_f32 v[38:39], v[38:39], v[46:47]
  s_waitcnt lgkmcnt(3)
  v_pk_add_f32 v[32:33], v[32:33], v[48:49]
  v_pk_add_f32 v[34:35], v[34:35], v[50:51]
  s_waitcnt lgkmcnt(2)
  v_pk_add_f32 v[36:37], v[36:37], v[52:53]
  v_pk_add_f32 v[38:39], v[38:39], v[54:55]
  s_waitcnt lgkmcnt(1)
  v_pk_add_f32 v[32:33], v[32:33], v[56:57]
  v_pk_add_f32 v[34:35], v[34:35], v[58:59]
  s_waitcnt lgkmcnt(0)
  v_pk_add_f32 v[36:37], v[36:37], v[60:61]
  v_pk_add_f32 v[38:39], v[38:39], v[62:63]
  v_pk_mul_f32 v[124:125], v[32:33], v[120:121]
  v_pk_mul_f32 v[126:127], v[34:35], v[120:121]
  v_pk_mul_f32 v[128:129], v[36:37], v[120:121]
  v_pk_mul_f32 v[130:131], v[38:39], v[120:121]
  v_exp_f32 v124, v124
  v_exp_f32 v125, v125
  v_exp_f32 v126, v126
  v_exp_f32 v127, v127
  v_exp_f32 v128, v128
  v_exp_f32 v129, v129
  v_exp_f32 v130, v130
  v_exp_f32 v131, v131
  v_pk_mul_f32 v[32:33], v[32:33], v[88:89]
  v_pk_mul_f32 v[34:35], v[34:35], v[90:91]
  v_pk_mul_f32 v[36:37], v[36:37], v[92:93]
  v_pk_mul_f32 v[38:39], v[38:39], v[94:95]
  v_pk_add_f32 v[124:125], v[124:125], v[122:123]
  v_pk_add_f32 v[126:127], v[126:127], v[122:123]
  v_pk_add_f32 v[128:129], v[128:129], v[122:123]
  v_pk_add_f32 v[130:131], v[130:131], v[122:123]
  v_rcp_f32 v124, v124
  v_rcp_f32 v125, v125
  v_rcp_f32 v126, v126
  v_rcp_f32 v127, v127
  v_rcp_f32 v128, v128
  v_rcp_f32 v129, v129
  v_rcp_f32 v130, v130
  v_rcp_f32 v131, v131
  v_pk_fma_f32 v[124:125], v[124:125], v[32:33], v[72:73]
  v_pk_fma_f32 v[126:127], v[126:127], v[34:35], v[74:75]
  v_pk_fma_f32 v[128:129], v[128:129], v[36:37], v[76:77]
  v_pk_fma_f32 v[130:131], v[130:131], v[38:39], v[78:79]
  v_cvt_pk_bf16_f32 v136, v124, v125
  v_cvt_pk_bf16_f32 v137, v126, v127
  v_cvt_pk_bf16_f32 v138, v128, v129
  v_cvt_pk_bf16_f32 v139, v130, v131
  buffer_store_dwordx4 v[136:139], v248, s[40:43], s71 offen sc1
L_end:
  s_endpgm
L_code_end:
.section .rodata,"a"
.p2align 6
.amdhsa_kernel recurrent_scan__ssm_conv_h3__dense_activation_gelu__prompt_kernel
  .amdhsa_next_free_vgpr 256
  .amdhsa_next_free_sgpr 102
  .amdhsa_accum_offset 256
  .amdhsa_group_segment_fixed_size 0
  .amdhsa_kernarg_size 112
  .amdhsa_user_sgpr_count 2
  .amdhsa_user_sgpr_kernarg_segment_ptr 1
  .amdhsa_system_sgpr_workgroup_id_x 1
.end_amdhsa_kernel
```
